```python
import torch

def _softmax(x, axis=-1):
    return torch.softmax(x, dim=axis)
def _gelu(x):
    return torch.nn.functional.gelu(x, approximate="tanh")
def _silu(x):
    return torch.nn.functional.silu(x)
def _sigmoid(x):
    return torch.sigmoid(x)
def _layernorm(x, axis=-1, eps=1e-5):
    m = x.mean(dim=axis, keepdim=True)
    v = x.var(dim=axis, keepdim=True, unbiased=False)
    return (x - m) / torch.sqrt(v + eps)
def _scatter_add(tgt, idx, src, axis=0):
    return tgt.clone().index_add_(axis, idx, src)
def _segment_sum(src, seg, n):
    out = torch.zeros((n,) + src.shape[1:], dtype=src.dtype)
    return out.index_add_(0, seg, src)
def _pad(x, pw):
    flat = tuple(v for pair in reversed(pw) for v in pair)
    return torch.nn.functional.pad(x, flat)

kernel_name = 'gated_mix__grouped_kv_mqa__spectral_fnet__prompt'

def setup_inputs():

    _w = (lambda a: (lambda t: t.to(torch.bfloat16) if t.is_floating_point() else t)(torch.as_tensor(a)))
    def _A_setup():
        B, S, D, H = 1, 2048, 640, 32
        Dh = D // H
        return {
            "x": _w((lambda *s: torch.randn(*s, dtype=torch.bfloat16) * 0.05)(B, S, D)),
            "wq": _w((lambda *s: torch.randn(*s, dtype=torch.bfloat16) * 1.6)(D, H * Dh)),
            "wk": _w((lambda *s: torch.randn(*s, dtype=torch.bfloat16) * 1.6)(D, Dh)),
            "wv": _w((lambda *s: torch.randn(*s, dtype=torch.bfloat16) * 1.6)(D, Dh)),
            "wo": _w((lambda *s: torch.randn(*s, dtype=torch.bfloat16) * 1.6)(H * Dh, D)),
        }
    _A_in = _A_setup()

    def _B_setup():
        B, S, D = 1, 2048, 640
        ns = torch.arange(S)[:, None] * torch.arange(S)[None, :]
        nd = torch.arange(D)[:, None] * torch.arange(D)[None, :]
        Ws_re = torch.cos(-2.0 * torch.pi * ns / S).to(float)
        Ws_im = torch.sin(-2.0 * torch.pi * ns / S).to(float)
        Wd_re = torch.cos(-2.0 * torch.pi * nd / D).to(float)
        Wd_im = torch.sin(-2.0 * torch.pi * nd / D).to(float)
        return {
            "x": _w((lambda *s: torch.randn(*s, dtype=torch.bfloat16) * 0.05)(B, S, D)),
            "dft_seq_re": _w(Ws_re),
            "dft_seq_im": _w(Ws_im),
            "dft_hid_re": _w(Wd_re),
            "dft_hid_im": _w(Wd_im),
        }
    _B_in = _B_setup()

    return {
        "A_x": _A_in["x"],
        "A_wq": _A_in["wq"],
        "A_wk": _A_in["wk"],
        "A_wv": _A_in["wv"],
        "A_wo": _A_in["wo"],
        "B_x": _B_in["x"],
        "B_dft_seq_re": _B_in["dft_seq_re"],
        "B_dft_seq_im": _B_in["dft_seq_im"],
        "B_dft_hid_re": _B_in["dft_hid_re"],
        "B_dft_hid_im": _B_in["dft_hid_im"],
        "gate_w": _w((lambda *s: torch.randn(*s, dtype=torch.bfloat16) * 0.05)(640) * 16.0),
    }

def reference(A_x, A_wq, A_wk, A_wv, A_wo, B_x, B_dft_seq_re, B_dft_seq_im, B_dft_hid_re, B_dft_hid_im, gate_w):
    def _A_ref(x, wq, wk, wv, wo):
        B, S, D = x.shape
        H = 32
        Dh = D // H
        q = (lambda x, *d: x.permute(*d))((x @ wq).reshape(B, S, H, Dh), 0, 2, 1, 3)
        k = x @ wk
        v = x @ wv
        scores = torch.einsum("bhqd,bkd->bhqk", q, k) * (Dh ** -0.5)
        p = _softmax(scores, axis=-1)
        o = torch.einsum("bhqk,bkd->bhqd", p, v)
        return (lambda x, *d: x.permute(*d))(o, 0, 2, 1, 3).reshape(B, S, H * Dh) @ wo

    def _B_ref(x, dft_seq_re, dft_seq_im, dft_hid_re, dft_hid_im):
        a = torch.einsum("bsd,ed->bse", x, dft_hid_re)
        b = torch.einsum("bsd,ed->bse", x, dft_hid_im)
        y = torch.einsum("ts,bse->bte", dft_seq_re, a) - torch.einsum("ts,bse->bte", dft_seq_im, b)
        return y

    x = A_x
    g = _sigmoid((x * gate_w).sum(-1, keepdims=True))
    a = _A_ref(x, A_wq, A_wk, A_wv, A_wo)
    b = _B_ref(x, B_dft_seq_re, B_dft_seq_im, B_dft_hid_re, B_dft_hid_im)
    return g * a + (1 - g) * b
```

```asm
; @launch grid=(256,1,1) block=(768,1,1) lds=163840
.amdgcn_target "amdgcn-amd-amdhsa--gfx950"
.text
.globl gated_mix__grouped_kv_mqa__spectral_fnet__prompt_kernel
.p2align 8
.type gated_mix__grouped_kv_mqa__spectral_fnet__prompt_kernel,@function
gated_mix__grouped_kv_mqa__spectral_fnet__prompt_kernel:
    s_cmp_ge_u32 s2, 256
    s_cbranch_scc1 Lend
    v_lshrrev_b32 v1, 6, v0
    v_and_b32 v0, 63, v0
    v_mov_b32 v15, 162288
    v_readfirstlane_b32 s3, v1
    v_lshlrev_b32 v1, 4, v0
    s_lshr_b32 s7, s2, 3
    s_cmp_lg_u32 s3, 11
    s_cbranch_scc1 Lp_noinit
    s_getpc_b64 s[44:45]
Lpcbase:
    s_lshl_b32 s47, s7, 10
    v_add_u32 v2, s47, v1
    v_min_u32 v2, (Lend-Lpcbase-16)&0xfffffff0, v2
    v_add_co_u32 v2, vcc, s44, v2
    v_mov_b32 v3, s45
    s_nop 0
    v_addc_co_u32 v3, vcc, 0, v3, vcc
    global_load_dwordx4 v[100:103], v[2:3], off
    v_lshl_add_u32 v8, v0, 2, v15
    v_mov_b32 v9, 0
    ds_write_b32 v8, v9
    s_waitcnt lgkmcnt(0)
Lp_noinit:
    s_load_dwordx16 s[64:79], s[0:1], 0
    s_load_dwordx8 s[80:87], s[0:1], 64
    s_load_dwordx4 s[88:91], s[0:1], 96
    s_and_b32 s6, s2, 7
    s_and_b32 s4, s7, 3
    s_lshl_b32 s44, s6, 2
    s_add_u32 s4, s4, s44
    s_lshr_b32 s5, s7, 2
    s_mov_b32 s92, 0x100000
    s_mov_b32 s94, 0x000FFFFF
    s_mov_b32 s95, 0x000FFFFF
    s_mov_b32 s93, s3
    s_sub_u32 s3, s3, 4
    s_mov_b32 s10, 2621440
    s_mov_b32 s11, 0x00020000
    s_mov_b32 s14, 819200
    s_mov_b32 s15, 0x00020000
    s_mov_b32 s18, 25600
    s_mov_b32 s19, 0x00020000
    s_mov_b32 s22, 819200
    s_mov_b32 s23, 0x00020000
    s_mov_b32 s26, 24117248
    s_mov_b32 s27, 0x00020000
    s_mov_b32 s30, 2621440
    s_mov_b32 s31, 0x00020000
    s_mov_b32 s38, 1280
    s_mov_b32 s39, 0x00020000
    s_mov_b32 s42, 819200
    s_mov_b32 s43, 0x00020000
    v_mov_b32 v14, 1
    v_mov_b32 v4, 1073741824
    s_movk_i32 s46, 1280
    s_cmp_lt_u32 s93, 4
    s_cbranch_scc1 Lld
    s_cmp_lt_u32 s93, 8
    s_cbranch_scc1 Lkvp
    s_barrier
    s_branch Lidle
Lkvp:
    s_setprio 3
    s_lshl_b32 s54, s4, 6
    s_and_b32 s44, s5, 3
    s_lshl_b32 s44, s44, 4
    s_add_u32 s54, s54, s44
    s_mul_i32 s55, s3, 6400
    v_add_u32 v2, s55, v1
    v_lshrrev_b32 v10, 2, v0
    v_add_u32 v10, s54, v10
    v_mul_lo_u32 v3, v10, s46
    v_lshrrev_b32 v11, 4, v0
    s_mul_i32 s44, s3, 320
    v_lshl_add_u32 v4, v11, 4, s44
    v_and_b32 v12, 48, v1
    v_add3_u32 v3, v3, v12, s44
    s_add_u32 s55, s55, 110592
    s_mov_b32 m0, s55
    v_mov_b32 v9, 319488
    s_barrier
    s_cmp_ge_u32 s5, 4
    s_waitcnt lgkmcnt(0)
    s_cselect_b32 s16, s70, s68
    s_cselect_b32 s17, s71, s69
    s_mov_b32 s8, s64
    s_mov_b32 s9, s65
    s_mov_b32 s12, s66
    s_mov_b32 s13, s67
    s_mov_b32 s20, s72
    s_mov_b32 s21, s73
    s_mov_b32 s24, s90
    s_mov_b32 s25, s91
    s_mov_b32 s28, s86
    s_mov_b32 s29, s87
    s_mov_b32 s36, s84
    s_mov_b32 s37, s85
    s_mov_b32 s40, s80
    s_mov_b32 s41, s81
    buffer_load_dwordx4 v[96:99], v3, s[8:11], 0 offen offset:0
    buffer_load_dwordx4 v[100:103], v3, s[8:11], 0 offen offset:64
    buffer_load_dwordx4 v[104:107], v3, s[8:11], 0 offen offset:128
    buffer_load_dwordx4 v[108:111], v3, s[8:11], 0 offen offset:192
    buffer_load_dwordx4 v[112:115], v3, s[8:11], 0 offen offset:256
    buffer_load_dwordx4 v2, s[16:19], 0 offen offset:0 lds
    buffer_load_dwordx4 v2, s[16:19], 0 offen offset:1024 lds
    buffer_load_dwordx4 v2, s[16:19], 0 offen offset:2048 lds
    buffer_load_dwordx4 v2, s[16:19], 0 offen offset:3072 lds
    s_add_u32 m0, s55, 4096
    s_movk_i32 s44, 4096
    buffer_load_dwordx4 v2, s[16:19], s44 offen lds
    buffer_load_dwordx4 v2, s[16:19], s44 offen offset:1024 lds
    s_mov_b64 exec, 0xffff
    buffer_load_dwordx4 v2, s[16:19], s44 offen offset:2048 lds
    s_mov_b64 exec, -1
    s_cmp_lt_u32 s5, 4
    s_cselect_b32 s44, 1073741824, 0
    buffer_load_dwordx4 v[36:39], v4, s[36:39], s44 offen offset:0
    buffer_load_dwordx4 v[40:43], v4, s[36:39], s44 offen offset:64
    buffer_load_dwordx4 v[44:47], v4, s[36:39], s44 offen offset:128
    buffer_load_dwordx4 v[48:51], v4, s[36:39], s44 offen offset:192
    buffer_load_dwordx4 v[52:55], v4, s[36:39], s44 offen offset:256
    s_cmp_eq_u32 s3, 0
    s_cselect_b32 s44, 0, 1073741824
    s_mov_b64 exec, 1
    buffer_load_dword v9, v9, s[24:27], s44 offen sc1
    s_mov_b64 exec, -1
    s_branch Lkvp2
Lld:
    s_setprio 2
    s_add_u32 s3, s93, 8
    s_lshr_b32 s56, s93, 1
    s_and_b32 s57, s93, 1
    s_lshl_b32 s44, s4, 6
    s_lshl_b32 s45, s57, 5
    s_add_u32 s44, s44, s45
    v_lshrrev_b32 v11, 2, v0
    v_add_u32 v11, s44, v11
    v_mul_lo_u32 v7, v11, s46
    v_lshrrev_b32 v12, 4, v0
    v_and_b32 v13, 3, v0
    v_xor_b32 v12, v12, v13
    v_lshl_add_u32 v7, v12, 4, v7
    s_mul_i32 s44, s56, 18432
    s_lshl_b32 s33, s57, 12
    s_add_u32 s33, s33, s44
    s_mul_i32 s34, s57, 5120
    s_add_u32 s34, s34, s44
    s_add_u32 s34, s34, 8192
    s_lshl_b32 s35, s56, 7
    s_mul_i32 s52, s93, 40960
    s_and_b32 s44, s7, 3
    s_add_u32 s44, s44, s5
    s_cmp_ge_u32 s44, 5
    s_cselect_b32 s45, 5, 0
    s_sub_u32 s44, s44, s45
    s_cmp_ge_u32 s44, 5
    s_cselect_b32 s45, 5, 0
    s_sub_u32 s44, s44, s45
    s_lshl_b32 s45, s44, 8
    s_add_u32 s35, s35, s45
    s_mul_i32 s45, s44, 163840
    s_add_u32 s52, s52, s45
    s_mul_i32 s45, s5, 160
    s_movk_i32 s47, 205
    s_barrier
    s_cmp_ge_u32 s5, 4
    s_waitcnt lgkmcnt(0)
    s_cselect_b32 s16, s70, s68
    s_cselect_b32 s17, s71, s69
    s_mov_b32 s8, s64
    s_mov_b32 s9, s65
    s_mov_b32 s12, s66
    s_mov_b32 s13, s67
    s_mov_b32 s20, s72
    s_mov_b32 s21, s73
    s_mov_b32 s24, s90
    s_mov_b32 s25, s91
    s_mov_b32 s28, s86
    s_mov_b32 s29, s87
    s_mov_b32 s36, s84
    s_mov_b32 s37, s85
    s_mov_b32 s40, s80
    s_mov_b32 s41, s81
    s_add_u32 m0, s33, 73728
    s_add_u32 s53, s35, 0
    buffer_load_dwordx4 v7, s[8:11], s53 offen offset:0 lds
    s_add_u32 m0, s33, 74688
    s_nop 0
    buffer_load_dwordx4 v7, s[8:11], s53 offen offset:64 lds
    s_add_u32 m0, s33, 75776
    s_add_u32 s53, s35, 20480
    buffer_load_dwordx4 v7, s[8:11], s53 offen offset:0 lds
    s_add_u32 m0, s33, 76736
    s_nop 0
    buffer_load_dwordx4 v7, s[8:11], s53 offen offset:64 lds
    v_add_u32 v8, 0, v0
    v_mul_lo_u32 v11, v8, s47
    v_lshrrev_b32 v11, 11, v11
    v_mul_u32_u24 v12, 10, v11
    v_sub_u32 v12, v8, v12
    v_lshl_add_u32 v12, v12, 4, s45
    v_and_b32 v13, 24, v11
    v_bfe_u32 v8, v11, 1, 2
    v_or_b32 v13, v13, v8
    v_and_b32 v8, 1, v11
    v_lshl_add_u32 v13, v8, 2, v13
    v_mad_u32_u24 v2, v13, s46, v12
    s_add_u32 m0, s34, 73728
    s_nop 0
    buffer_load_dwordx4 v2, s[12:15], s52 offen lds
    v_add_u32 v8, 64, v0
    v_mul_lo_u32 v11, v8, s47
    v_lshrrev_b32 v11, 11, v11
    v_mul_u32_u24 v12, 10, v11
    v_sub_u32 v12, v8, v12
    v_lshl_add_u32 v12, v12, 4, s45
    v_and_b32 v13, 24, v11
    v_bfe_u32 v8, v11, 1, 2
    v_or_b32 v13, v13, v8
    v_and_b32 v8, 1, v11
    v_lshl_add_u32 v13, v8, 2, v13
    v_mad_u32_u24 v3, v13, s46, v12
    s_add_u32 m0, s34, 74752
    s_nop 0
    buffer_load_dwordx4 v3, s[12:15], s52 offen lds
    v_add_u32 v8, 128, v0
    v_mul_lo_u32 v11, v8, s47
    v_lshrrev_b32 v11, 11, v11
    v_mul_u32_u24 v12, 10, v11
    v_sub_u32 v12, v8, v12
    v_lshl_add_u32 v12, v12, 4, s45
    v_and_b32 v13, 24, v11
    v_bfe_u32 v8, v11, 1, 2
    v_or_b32 v13, v13, v8
    v_and_b32 v8, 1, v11
    v_lshl_add_u32 v13, v8, 2, v13
    v_mad_u32_u24 v4, v13, s46, v12
    s_add_u32 m0, s34, 75776
    s_nop 0
    buffer_load_dwordx4 v4, s[12:15], s52 offen lds
    v_add_u32 v8, 192, v0
    v_mul_lo_u32 v11, v8, s47
    v_lshrrev_b32 v11, 11, v11
    v_mul_u32_u24 v12, 10, v11
    v_sub_u32 v12, v8, v12
    v_lshl_add_u32 v12, v12, 4, s45
    v_and_b32 v13, 24, v11
    v_bfe_u32 v8, v11, 1, 2
    v_or_b32 v13, v13, v8
    v_and_b32 v8, 1, v11
    v_lshl_add_u32 v13, v8, 2, v13
    v_mad_u32_u24 v5, v13, s46, v12
    s_add_u32 m0, s34, 76800
    s_nop 0
    buffer_load_dwordx4 v5, s[12:15], s52 offen lds
    v_add_u32 v8, 256, v0
    v_mul_lo_u32 v11, v8, s47
    v_lshrrev_b32 v11, 11, v11
    v_mul_u32_u24 v12, 10, v11
    v_sub_u32 v12, v8, v12
    v_lshl_add_u32 v12, v12, 4, s45
    v_and_b32 v13, 24, v11
    v_bfe_u32 v8, v11, 1, 2
    v_or_b32 v13, v13, v8
    v_and_b32 v8, 1, v11
    v_lshl_add_u32 v13, v8, 2, v13
    v_mad_u32_u24 v6, v13, s46, v12
    s_add_u32 m0, s34, 77824
    s_nop 0
    buffer_load_dwordx4 v6, s[12:15], s52 offen lds
    s_lshl_b32 s44, s93, 2
    v_add_u32 v90, s44, v15
    v_mov_b32 v91, 0
    v_add_u32 v12, 4096, v1
    v_mov_b32 v92, 1073741824
    s_cmp_eq_u32 s93, 3
    s_cbranch_scc1 Ll_s3
    s_mul_i32 s60, s7, 3
    s_add_u32 s60, s60, s93
    s_lshr_b32 s44, s60, 1
    s_lshl_b32 s44, s44, 3
    s_add_u32 s61, s44, s6
    s_sub_u32 s48, s6, s44
    s_add_u32 s48, s48, 376
    s_cmp_lt_u32 s48, 340
    s_cselect_b32 s62, 1, 0
    s_bitcmp1_b32 s60, 0
    s_cselect_b32 s62, 0, s62
    s_cselect_b32 s44, 0, 384
    s_add_u32 s61, s61, s44
    s_mul_i32 s45, s48, 205
    s_lshr_b32 s45, s45, 12
    s_mul_i32 s46, s45, 20
    s_sub_u32 s46, s48, s46
    s_and_b32 s47, s48, 0xfffffffc
    s_lshl_b32 s47, s47, 10
    s_and_b32 s44, s46, 3
    s_lshl_b32 s49, s44, 7
    s_add_u32 s47, s47, s49
    s_add_u32 s47, s47, 1048576
    s_lshl_b32 s58, s61, 7
    s_add_u32 s58, s58, 622592
    s_lshl_b32 s48, s48, 7
    s_add_u32 s48, s48, 524288
    s_cmp_eq_u32 s62, 1
    s_cselect_b32 s48, s48, 1073741824
    s_cmp_lt_u32 s46, 4
    s_cselect_b32 s63, 0xfefefefe, -1
    s_lshl2_add_u32 s49, s45, s44
    s_lshl_b32 s49, s49, 5
    s_add_u32 s91, s49, 983040
    s_cmp_ge_u32 s46, 16
    s_cselect_b32 s91, s91, 1073741824
    v_mov_b32 v128, 0
    v_mov_b32 v129, 0
    v_mov_b32 v130, 0
    v_mov_b32 v131, 0
    v_lshrrev_b32 v144, 3, v0
    v_and_b32 v140, 3, v144
    v_lshrrev_b32 v141, 5, v0
    v_lshl_add_u32 v140, v141, 3, v140
    s_lshl_b32 s45, s45, 5
    s_lshr_b32 s49, s44, 1
    s_lshl_b32 s49, s49, 4
    s_add_u32 s45, s45, s49
    s_and_b32 s49, s44, 1
    s_lshl_b32 s49, s49, 2
    s_add_u32 s45, s45, s49
    v_add_u32 v140, s45, v140
    v_lshlrev_b32 v141, 4, v141
    v_and_b32 v145, 0x70, v1
    s_lshr_b32 s46, s46, 2
    s_lshl_b32 s46, s46, 7
    v_add_u32 v142, s46, v145
    s_movk_i32 s46, 1280
    v_mul_lo_u32 v143, v140, s46
    v_add_u32 v132, v143, v142
    v_sub_u32 v133, v142, v143
    v_add_u32 v135, 2621440, v133
    v_add_u32 v133, 1310720, v133
    v_add_u32 v134, 1310720, v132
    v_mov_b32 v138, 1073741824
    v_cmp_eq_u32 vcc, 0, v140
    s_movk_i32 s45, 512
    s_nop 0
    v_cndmask_b32 v134, v134, v138, vcc
    v_cmp_le_u32 vcc, s45, v140
    s_nop 1
    v_cndmask_b32 v133, v133, v138, vcc
    v_cndmask_b32 v134, v134, v138, vcc
    v_cmp_lt_u32 vcc, s45, v140
    s_nop 1
    v_cndmask_b32 v132, v132, v138, vcc
    v_cndmask_b32 v135, v135, v138, vcc
    v_cmp_eq_u32 vcc, 0x70, v145
    v_lshlrev_b32 v143, 2, v144
    v_lshlrev_b32 v142, 1, v142
    v_cndmask_b32 v143, v138, v143, vcc
    v_sub_u32 v138, 1264, v142
    s_cmp_lt_u32 s61, 105
    s_cbranch_scc0 Lrp_ws
    s_mul_i32 s45, s61, 103
    s_lshr_b32 s45, s45, 9
    s_mul_i32 s46, s45, 5
    s_sub_u32 s46, s61, s46
    s_cmp_lt_u32 s45, 11
    s_cselect_b32 s40, s80, s82
    s_cselect_b32 s41, s81, s83
    s_cselect_b32 s49, 0, 11
    s_sub_u32 s49, s45, s49
    s_mul_i32 s49, s49, 40960
    s_movk_i32 s50, 1280
    s_mul_i32 s56, s45, 20480
    s_add_u32 s56, s56, 4194304
    s_mov_b32 s57, 1073741824
    s_branch Lrp_go
Lrp_ws:
    s_sub_u32 s46, s61, 105
    s_lshr_b32 s45, s46, 3
    s_and_b32 s46, s46, 7
    s_cmp_ge_u32 s45, 33
    s_cselect_b32 s40, s78, s76
    s_cselect_b32 s41, s79, s77
    s_mov_b32 s42, 8388608
    s_cselect_b32 s49, 33, 0
    s_sub_u32 s49, s45, s49
    s_mul_i32 s56, s45, 33792
    s_add_u32 s56, s56, 5242880
    s_lshl_b32 s50, s49, 6
    s_cmp_ge_u32 s49, 16
    s_cselect_b32 s51, 1023, 0
    s_sub_u32 s50, s50, s51
    s_cmp_eq_u32 s49, 32
    s_cselect_b32 s49, 1024, s50
    s_lshl_b32 s49, s49, 12
    s_movk_i32 s50, 8192
    s_cmp_eq_u32 s46, 7
    s_cselect_b32 s57, 0, 1073741824
    s_cmp_lt_u32 s45, 65
    s_cselect_b32 s49, s49, 1073741824
    s_cselect_b32 s56, s56, 1073741824
    s_cselect_b32 s58, s58, 1073741824
Lrp_go:
    v_and_b32 v136, 31, v0
    v_mul_lo_u32 v136, v136, s50
    v_add_u32 v136, v136, v141
    v_mul_lo_u32 v140, v144, s50
    v_add_u32 v140, v140, v145
    s_lshl_b32 s51, s46, 7
    s_add_u32 s49, s49, s51
    v_add_u32 v136, s49, v136
    v_add_u32 v140, s49, v140
    s_lshl_b32 s50, s50, 3
    s_lshl_b32 s51, s46, 12
    s_add_u32 s56, s56, s51
    v_mov_b32 v137, s58
    v_mov_b32 v139, s48
    v_lshlrev_b32 v141, 1, v145
    v_lshl_add_u32 v141, v144, 2, v141
    v_lshl_add_u32 v142, v144, 9, v145
    s_lshl_b32 s51, s50, 1
    s_add_u32 s59, s51, s50
Ll_s3r:
    s_add_u32 s35, s35, 256
    s_add_u32 s52, s52, 163840
    s_cmp_ge_u32 s35, 1280
    s_cselect_b32 s54, 1280, 0
    s_cselect_b32 s55, 819200, 0
    s_sub_u32 s35, s35, s54
    s_sub_u32 s52, s52, s55
    s_add_u32 m0, s33, 0
    s_add_u32 s53, s35, 0
    buffer_load_dwordx4 v7, s[8:11], s53 offen offset:0 lds
    s_add_u32 m0, s33, 960
    s_nop 0
    buffer_load_dwordx4 v7, s[8:11], s53 offen offset:64 lds
    s_add_u32 m0, s33, 2048
    s_add_u32 s53, s35, 20480
    buffer_load_dwordx4 v7, s[8:11], s53 offen offset:0 lds
    s_add_u32 m0, s33, 3008
    s_nop 0
    buffer_load_dwordx4 v7, s[8:11], s53 offen offset:64 lds
    s_add_u32 m0, s34, 0
    s_nop 0
    buffer_load_dwordx4 v2, s[12:15], s52 offen lds
    s_add_u32 m0, s34, 1024
    s_nop 0
    buffer_load_dwordx4 v3, s[12:15], s52 offen lds
    s_add_u32 m0, s34, 2048
    s_nop 0
    buffer_load_dwordx4 v4, s[12:15], s52 offen lds
    s_add_u32 m0, s34, 3072
    s_nop 0
    buffer_load_dwordx4 v5, s[12:15], s52 offen lds
    s_add_u32 m0, s34, 4096
    s_nop 0
    buffer_load_dwordx4 v6, s[12:15], s52 offen lds
    s_waitcnt vmcnt(9)
    v_add_u32 v91, 1, v91
    ds_write_b32 v90, v91 offset:64
    s_add_u32 s35, s35, 256
    s_add_u32 s52, s52, 163840
    s_cmp_ge_u32 s35, 1280
    s_cselect_b32 s54, 1280, 0
    s_cselect_b32 s55, 819200, 0
    s_sub_u32 s35, s35, s54
    s_sub_u32 s52, s52, s55
    s_add_u32 m0, s33, 36864
    s_add_u32 s53, s35, 0
    buffer_load_dwordx4 v7, s[8:11], s53 offen offset:0 lds
    s_add_u32 m0, s33, 37824
    s_nop 0
    buffer_load_dwordx4 v7, s[8:11], s53 offen offset:64 lds
    s_add_u32 m0, s33, 38912
    s_add_u32 s53, s35, 20480
    buffer_load_dwordx4 v7, s[8:11], s53 offen offset:0 lds
    s_add_u32 m0, s33, 39872
    s_nop 0
    buffer_load_dwordx4 v7, s[8:11], s53 offen offset:64 lds
    s_add_u32 m0, s34, 36864
    s_nop 0
    buffer_load_dwordx4 v2, s[12:15], s52 offen lds
    s_add_u32 m0, s34, 37888
    s_nop 0
    buffer_load_dwordx4 v3, s[12:15], s52 offen lds
    s_add_u32 m0, s34, 38912
    s_nop 0
    buffer_load_dwordx4 v4, s[12:15], s52 offen lds
    s_add_u32 m0, s34, 39936
    s_nop 0
    buffer_load_dwordx4 v5, s[12:15], s52 offen lds
    s_add_u32 m0, s34, 40960
    s_nop 0
    buffer_load_dwordx4 v6, s[12:15], s52 offen lds
    s_waitcnt vmcnt(9)
    v_add_u32 v91, 1, v91
    ds_write_b32 v90, v91 offset:64
    s_add_u32 s35, s35, 256
    s_add_u32 s52, s52, 163840
    s_cmp_ge_u32 s35, 1280
    s_cselect_b32 s54, 1280, 0
    s_cselect_b32 s55, 819200, 0
    s_sub_u32 s35, s35, s54
    s_sub_u32 s52, s52, s55
Lw1:
    ds_read_b32 v13, v15 offset:16
    s_waitcnt lgkmcnt(0)
    v_readfirstlane_b32 s55, v13
    s_cmp_ge_u32 s55, 1
    s_cbranch_scc1 Lwd2
    s_sub_u32 s92, s92, 1
    s_cbranch_scc1 Lwd2
    s_branch Lw1
Lwd2:
    s_add_u32 m0, s33, 110592
    s_add_u32 s53, s35, 0
    buffer_load_dwordx4 v7, s[8:11], s53 offen offset:0 lds
    s_add_u32 m0, s33, 111552
    s_nop 0
    buffer_load_dwordx4 v7, s[8:11], s53 offen offset:64 lds
    s_add_u32 m0, s33, 112640
    s_add_u32 s53, s35, 20480
    buffer_load_dwordx4 v7, s[8:11], s53 offen offset:0 lds
    s_add_u32 m0, s33, 113600
    s_nop 0
    buffer_load_dwordx4 v7, s[8:11], s53 offen offset:64 lds
    s_add_u32 m0, s34, 110592
    s_nop 0
    buffer_load_dwordx4 v2, s[12:15], s52 offen lds
    s_add_u32 m0, s34, 111616
    s_nop 0
    buffer_load_dwordx4 v3, s[12:15], s52 offen lds
    s_add_u32 m0, s34, 112640
    s_nop 0
    buffer_load_dwordx4 v4, s[12:15], s52 offen lds
    s_add_u32 m0, s34, 113664
    s_nop 0
    buffer_load_dwordx4 v5, s[12:15], s52 offen lds
    s_add_u32 m0, s34, 114688
    s_nop 0
    buffer_load_dwordx4 v6, s[12:15], s52 offen lds
    s_waitcnt vmcnt(9)
    v_add_u32 v91, 1, v91
    ds_write_b32 v90, v91 offset:64
    s_add_u32 s35, s35, 256
    s_add_u32 s52, s52, 163840
    s_cmp_ge_u32 s35, 1280
    s_cselect_b32 s54, 1280, 0
    s_cselect_b32 s55, 819200, 0
    s_sub_u32 s35, s35, s54
    s_sub_u32 s52, s52, s55
Lw3:
    ds_read_b32 v13, v15 offset:4
    s_waitcnt lgkmcnt(0)
    v_readfirstlane_b32 s55, v13
    s_cmp_ge_u32 s55, 8
    s_cbranch_scc1 Lwd4
    s_sub_u32 s92, s92, 1
    s_cbranch_scc1 Lwd4
    s_branch Lw3
Lwd4:
    s_add_u32 m0, s33, 73728
    s_add_u32 s53, s35, 0
    buffer_load_dwordx4 v7, s[8:11], s53 offen offset:0 lds
    s_add_u32 m0, s33, 74688
    s_nop 0
    buffer_load_dwordx4 v7, s[8:11], s53 offen offset:64 lds
    s_add_u32 m0, s33, 75776
    s_add_u32 s53, s35, 20480
    buffer_load_dwordx4 v7, s[8:11], s53 offen offset:0 lds
    s_add_u32 m0, s33, 76736
    s_nop 0
    buffer_load_dwordx4 v7, s[8:11], s53 offen offset:64 lds
    s_add_u32 m0, s34, 73728
    s_nop 0
    buffer_load_dwordx4 v2, s[12:15], s52 offen lds
    s_add_u32 m0, s34, 74752
    s_nop 0
    buffer_load_dwordx4 v3, s[12:15], s52 offen lds
    s_add_u32 m0, s34, 75776
    s_nop 0
    buffer_load_dwordx4 v4, s[12:15], s52 offen lds
    s_add_u32 m0, s34, 76800
    s_nop 0
    buffer_load_dwordx4 v5, s[12:15], s52 offen lds
    s_add_u32 m0, s34, 77824
    s_nop 0
    buffer_load_dwordx4 v6, s[12:15], s52 offen lds
    s_waitcnt vmcnt(9)
    v_add_u32 v91, 1, v91
    ds_write_b32 v90, v91 offset:64
    s_cmp_eq_u32 s93, 3
    s_cbranch_scc1 Ll_h3
    s_cmp_eq_u32 s62, 0
    s_cbranch_scc1 Ll_nf
    v_add_u32 v2, v138, v132
    buffer_load_dwordx4 v[96:99], v132, s[8:11], 0 offen
    v_add_u32 v3, v138, v133
    buffer_load_dwordx4 v[100:103], v133, s[8:11], 0 offen
    v_add_u32 v4, v138, v134
    buffer_load_dwordx4 v[104:107], v134, s[8:11], 0 offen
    v_add_u32 v5, v138, v135
    buffer_load_dwordx4 v[108:111], v135, s[8:11], 0 offen
    buffer_load_dwordx4 v[112:115], v2, s[8:11], 0 offen
    buffer_load_dwordx4 v[116:119], v3, s[8:11], 0 offen
    buffer_load_dwordx4 v[120:123], v4, s[8:11], 0 offen
    buffer_load_dwordx4 v[124:127], v5, s[8:11], 0 offen
    s_waitcnt vmcnt(8)
    v_add_u32 v91, 1, v91
    ds_write_b32 v90, v91 offset:64
    s_mov_b32 exec_lo, s63
    s_mov_b32 exec_hi, s63
    buffer_load_dword v128, v2, s[8:11], 0 offen offset:16
    buffer_load_dword v129, v3, s[8:11], 0 offen offset:16
    buffer_load_dword v130, v4, s[8:11], 0 offen offset:16
    buffer_load_dword v131, v5, s[8:11], 0 offen offset:16
    s_mov_b64 exec, -1
    buffer_load_dwordx4 v[144:147], v140, s[40:43], 0 offen
    buffer_load_dwordx4 v[148:151], v140, s[40:43], s50 offen
    buffer_load_dwordx4 v[152:155], v140, s[40:43], s51 offen
    buffer_load_dwordx4 v[156:159], v140, s[40:43], s59 offen
    buffer_load_dwordx4 v[160:163], v136, s[40:43], s57 offen offset:128
    s_branch Lprep2
Ll_nf:
    buffer_load_dwordx4 v[144:147], v140, s[40:43], 0 offen
    buffer_load_dwordx4 v[148:151], v140, s[40:43], s50 offen
    buffer_load_dwordx4 v[152:155], v140, s[40:43], s51 offen
    buffer_load_dwordx4 v[156:159], v140, s[40:43], s59 offen
    buffer_load_dwordx4 v[160:163], v136, s[40:43], s57 offen offset:128
    s_waitcnt vmcnt(5)
    v_add_u32 v91, 1, v91
    ds_write_b32 v90, v91 offset:64
    s_branch Lprep2
Ll_s3:
    v_and_b32 v19, 15, v0
    v_bfe_u32 v20, v0, 4, 1
    v_lshrrev_b32 v17, 5, v0
    v_lshlrev_b32 v17, 3, v17
    v_mov_b32 v18, 1073741824
    v_lshl_add_u32 v16, v20, 5, v19
    v_lshl_add_u32 v85, v16, 4, v17
    v_cmp_gt_u32 vcc, 32, v0
    v_lshl_add_u32 v16, v20, 4, v19
    v_lshlrev_b32 v16, 2, v16
    v_add_u32 v16, 1024, v16
    v_cndmask_b32 v86, v18, v16, vcc
    v_xor_b32 v165, 192, v86
    v_mul_u32_u24 v20, 20, v20
    v_add_u32 v16, v20, v19
    v_add_u32 v17, 1280, v17
    v_lshl_add_u32 v87, v16, 4, v17
    v_and_b32 v16, 3, v0
    v_add3_u32 v16, v16, v20, 16
    v_lshl_add_u32 v16, v16, 4, v17
    v_and_b32 v20, 4, v0
    v_cmp_gt_u32 vcc, 8, v19
    v_add_u32 v16, v16, v20
    v_lshrrev_b32 v20, 4, v0
    v_cndmask_b32 v88, v18, v16, vcc
    v_lshl_add_u32 v16, v20, 2, v19
    v_lshlrev_b32 v16, 2, v16
    v_add_u32 v16, 162512, v16
    v_and_b32 v20, 12, v0
    v_cmp_eq_u32 vcc, 8, v20
    v_add_u32 v93, 157136, v85
    v_add_u32 v94, 157136, v86
    v_add_u32 v95, 157136, v87
    v_add_u32 v164, 157136, v88
    v_cndmask_b32 v89, v18, v16, vcc
    v_add_u32 v166, 157136, v165
    v_lshrrev_b32 v17, 1, v0
    v_xor_b32 v17, s4, v17
    v_lshlrev_b32 v17, 7, v17
    v_and_b32 v19, 1, v0
    v_lshl_add_u32 v17, v19, 4, v17
    v_add_u32 v92, 262144, v17
    v_mov_b32 v80, 0x3F803F80
    v_mov_b32 v81, 0x3F803F80
    v_mov_b32 v82, 0x3F803F80
    v_mov_b32 v83, 0x3F803F80
    v_mul_u32_u24 v84, 2576, v0
    v_mov_b32 v132, v18
    v_mov_b32 v133, v18
    v_mov_b32 v134, v18
    v_mov_b32 v135, v18
    v_mov_b32 v136, v18
    v_mov_b32 v137, v18
    v_mov_b32 v138, v18
    v_mov_b32 v139, v18
    v_mov_b32 v140, v18
    v_mov_b32 v141, v18
    v_mov_b32 v142, v18
    v_mov_b32 v143, v18
    v_mov_b32 v144, v18
    v_mov_b32 v145, v18
    s_branch Ll_s3r
Ll_h3:
    s_xor_b32 s44, s4, 0
    s_lshl_b32 s44, s44, 13
    s_xor_b32 s45, s44, 0x2000
    buffer_load_dwordx4 v[96:99], v1, s[24:27], s44 offen offset:0 sc1
    buffer_load_dwordx4 v[100:103], v1, s[24:27], s44 offen offset:1024 sc1
    buffer_load_dwordx4 v[104:107], v1, s[24:27], s44 offen offset:2048 sc1
    buffer_load_dwordx4 v[108:111], v1, s[24:27], s44 offen offset:3072 sc1
    buffer_load_dwordx4 v[112:115], v12, s[24:27], s44 offen offset:0 sc1
    buffer_load_dwordx4 v[116:119], v12, s[24:27], s44 offen offset:1024 sc1
    buffer_load_dwordx4 v[120:123], v12, s[24:27], s44 offen offset:2048 sc1
    buffer_load_dwordx4 v[124:127], v12, s[24:27], s44 offen offset:3072 sc1
    buffer_load_dwordx4 v[128:131], v1, s[24:27], s45 offen offset:0 sc1
    buffer_load_dwordx4 v[132:135], v1, s[24:27], s45 offen offset:1024 sc1
    buffer_load_dwordx4 v[136:139], v1, s[24:27], s45 offen offset:2048 sc1
    buffer_load_dwordx4 v[140:143], v1, s[24:27], s45 offen offset:3072 sc1
    buffer_load_dwordx4 v[144:147], v12, s[24:27], s45 offen offset:0 sc1
    buffer_load_dwordx4 v[148:151], v12, s[24:27], s45 offen offset:1024 sc1
    buffer_load_dwordx4 v[152:155], v12, s[24:27], s45 offen offset:2048 sc1
    buffer_load_dwordx4 v[156:159], v12, s[24:27], s45 offen offset:3072 sc1
Lw5:
    ds_read_b32 v13, v15 offset:40
    s_waitcnt lgkmcnt(0)
    v_readfirstlane_b32 s32, v13
    s_cmp_ge_u32 s32, 1
    s_cbranch_scc1 Lwd6
    s_sub_u32 s92, s92, 1
    s_cbranch_scc1 Lwd6
    s_branch Lw5
Lwd6:
    v_mov_b32 v8, s32
Lw7:
    ds_read_b32 v13, v15 offset:8
    s_waitcnt lgkmcnt(0)
    v_readfirstlane_b32 s44, v13
    s_cmp_ge_u32 s44, 8
    s_cbranch_scc1 Lwd8
    s_sub_u32 s92, s92, 1
    s_cbranch_scc1 Lwd8
    s_branch Lw7
Lwd8:
    s_mov_b64 exec, 0x3fff
    ds_write_b128 v84, v[80:83] offset:2560
    s_mov_b64 exec, -1
    s_waitcnt vmcnt(16)
    v_add_u32 v91, 1, v91
    ds_write_b32 v90, v91 offset:64
    s_xor_b32 s44, s4, 2
    s_lshl_b32 s44, s44, 13
    s_xor_b32 s45, s44, 0x2000
    buffer_load_dwordx4 v[16:19], v1, s[24:27], s44 offen offset:0 sc1
    buffer_load_dwordx4 v[20:23], v1, s[24:27], s44 offen offset:1024 sc1
    buffer_load_dwordx4 v[24:27], v1, s[24:27], s44 offen offset:2048 sc1
    buffer_load_dwordx4 v[28:31], v1, s[24:27], s44 offen offset:3072 sc1
    buffer_load_dwordx4 v[32:35], v12, s[24:27], s44 offen offset:0 sc1
    buffer_load_dwordx4 v[36:39], v12, s[24:27], s44 offen offset:1024 sc1
    buffer_load_dwordx4 v[40:43], v12, s[24:27], s44 offen offset:2048 sc1
    buffer_load_dwordx4 v[44:47], v12, s[24:27], s44 offen offset:3072 sc1
    buffer_load_dwordx4 v[48:51], v1, s[24:27], s45 offen offset:0 sc1
    buffer_load_dwordx4 v[52:55], v1, s[24:27], s45 offen offset:1024 sc1
    buffer_load_dwordx4 v[56:59], v1, s[24:27], s45 offen offset:2048 sc1
    buffer_load_dwordx4 v[60:63], v1, s[24:27], s45 offen offset:3072 sc1
    buffer_load_dwordx4 v[64:67], v12, s[24:27], s45 offen offset:0 sc1
    buffer_load_dwordx4 v[68:71], v12, s[24:27], s45 offen offset:1024 sc1
    buffer_load_dwordx4 v[72:75], v12, s[24:27], s45 offen offset:2048 sc1
    buffer_load_dwordx4 v[76:79], v12, s[24:27], s45 offen offset:3072 sc1
Lh3b:
    s_setprio 3
    s_mov_b32 s56, 4
    s_mov_b32 s57, 18032
    s_waitcnt vmcnt(24)
Lc9:
    v_cmpx_eq_u32 vcc, s32, v99
    v_cmpx_eq_u32 vcc, s32, v103
    v_cmpx_eq_u32 vcc, s32, v107
    v_cmpx_eq_u32 vcc, s32, v111
    v_cmpx_eq_u32 vcc, s32, v115
    v_cmpx_eq_u32 vcc, s32, v119
    v_cmpx_eq_u32 vcc, s32, v123
    v_cmpx_eq_u32 vcc, s32, v127
    s_cmp_eq_u64 exec, -1
    s_mov_b64 exec, -1
    s_cbranch_scc1 Lcd10
    s_sub_u32 s92, s92, 1
    s_cbranch_scc1 Lcd10
    s_xor_b32 s44, s4, 0
    s_lshl_b32 s44, s44, 13
    s_xor_b32 s45, s44, 0x2000
    buffer_load_dwordx4 v[96:99], v1, s[24:27], s44 offen offset:0 sc1
    buffer_load_dwordx4 v[100:103], v1, s[24:27], s44 offen offset:1024 sc1
    buffer_load_dwordx4 v[104:107], v1, s[24:27], s44 offen offset:2048 sc1
    buffer_load_dwordx4 v[108:111], v1, s[24:27], s44 offen offset:3072 sc1
    buffer_load_dwordx4 v[112:115], v12, s[24:27], s44 offen offset:0 sc1
    buffer_load_dwordx4 v[116:119], v12, s[24:27], s44 offen offset:1024 sc1
    buffer_load_dwordx4 v[120:123], v12, s[24:27], s44 offen offset:2048 sc1
    buffer_load_dwordx4 v[124:127], v12, s[24:27], s44 offen offset:3072 sc1
    buffer_load_dwordx4 v[128:131], v1, s[24:27], s45 offen offset:0 sc1
    buffer_load_dwordx4 v[132:135], v1, s[24:27], s45 offen offset:1024 sc1
    buffer_load_dwordx4 v[136:139], v1, s[24:27], s45 offen offset:2048 sc1
    buffer_load_dwordx4 v[140:143], v1, s[24:27], s45 offen offset:3072 sc1
    buffer_load_dwordx4 v[144:147], v12, s[24:27], s45 offen offset:0 sc1
    buffer_load_dwordx4 v[148:151], v12, s[24:27], s45 offen offset:1024 sc1
    buffer_load_dwordx4 v[152:155], v12, s[24:27], s45 offen offset:2048 sc1
    buffer_load_dwordx4 v[156:159], v12, s[24:27], s45 offen offset:3072 sc1
    s_waitcnt vmcnt(0)
    s_branch Lc9
Lcd10:
    ds_write_b64 v93, v[96:97] offset:0
    ds_write_b32 v94, v98 offset:0
    ds_write_b64 v93, v[100:101] offset:256
    ds_write_b32 v166, v102 offset:0
    ds_write_b64 v85, v[104:105] offset:0
    ds_write_b32 v86, v106 offset:0
    ds_write_b64 v85, v[108:109] offset:256
    ds_write_b32 v165, v110 offset:0
    ds_write_b64 v95, v[112:113] offset:0
    ds_write_b32 v164, v114 offset:0
    ds_write_b32 v89, v114 offset:0
    ds_write_b64 v95, v[116:117] offset:640
    ds_write_b32 v164, v118 offset:640
    ds_write_b32 v89, v118 offset:64
    ds_write_b64 v87, v[120:121] offset:0
    ds_write_b32 v88, v122 offset:0
    ds_write_b32 v89, v122 offset:128
    ds_write_b64 v87, v[124:125] offset:640
    ds_write_b32 v88, v126 offset:640
    ds_write_b32 v89, v126 offset:192
    ds_write_b32 v15, v14 offset:32
    s_waitcnt vmcnt(16)
Lc11:
    v_cmpx_eq_u32 vcc, s32, v131
    v_cmpx_eq_u32 vcc, s32, v135
    v_cmpx_eq_u32 vcc, s32, v139
    v_cmpx_eq_u32 vcc, s32, v143
    v_cmpx_eq_u32 vcc, s32, v147
    v_cmpx_eq_u32 vcc, s32, v151
    v_cmpx_eq_u32 vcc, s32, v155
    v_cmpx_eq_u32 vcc, s32, v159
    s_cmp_eq_u64 exec, -1
    s_mov_b64 exec, -1
    s_cbranch_scc1 Lcd12
    s_sub_u32 s92, s92, 1
    s_cbranch_scc1 Lcd12
    s_xor_b32 s44, s4, 0
    s_lshl_b32 s44, s44, 13
    s_xor_b32 s45, s44, 0x2000
    buffer_load_dwordx4 v[96:99], v1, s[24:27], s44 offen offset:0 sc1
    buffer_load_dwordx4 v[100:103], v1, s[24:27], s44 offen offset:1024 sc1
    buffer_load_dwordx4 v[104:107], v1, s[24:27], s44 offen offset:2048 sc1
    buffer_load_dwordx4 v[108:111], v1, s[24:27], s44 offen offset:3072 sc1
    buffer_load_dwordx4 v[112:115], v12, s[24:27], s44 offen offset:0 sc1
    buffer_load_dwordx4 v[116:119], v12, s[24:27], s44 offen offset:1024 sc1
    buffer_load_dwordx4 v[120:123], v12, s[24:27], s44 offen offset:2048 sc1
    buffer_load_dwordx4 v[124:127], v12, s[24:27], s44 offen offset:3072 sc1
    buffer_load_dwordx4 v[128:131], v1, s[24:27], s45 offen offset:0 sc1
    buffer_load_dwordx4 v[132:135], v1, s[24:27], s45 offen offset:1024 sc1
    buffer_load_dwordx4 v[136:139], v1, s[24:27], s45 offen offset:2048 sc1
    buffer_load_dwordx4 v[140:143], v1, s[24:27], s45 offen offset:3072 sc1
    buffer_load_dwordx4 v[144:147], v12, s[24:27], s45 offen offset:0 sc1
    buffer_load_dwordx4 v[148:151], v12, s[24:27], s45 offen offset:1024 sc1
    buffer_load_dwordx4 v[152:155], v12, s[24:27], s45 offen offset:2048 sc1
    buffer_load_dwordx4 v[156:159], v12, s[24:27], s45 offen offset:3072 sc1
    s_waitcnt vmcnt(0)
    s_branch Lc11
Lcd12:
    ds_write_b64 v85, v[128:129] offset:2576
    ds_write_b32 v86, v130 offset:2576
    ds_write_b64 v85, v[132:133] offset:2832
    ds_write_b32 v165, v134 offset:2576
    ds_write_b64 v85, v[136:137] offset:5152
    ds_write_b32 v86, v138 offset:5152
    ds_write_b64 v85, v[140:141] offset:5408
    ds_write_b32 v165, v142 offset:5152
    ds_write_b64 v87, v[144:145] offset:2576
    ds_write_b32 v88, v146 offset:2576
    ds_write_b64 v87, v[148:149] offset:3216
    ds_write_b32 v88, v150 offset:3216
    ds_write_b64 v87, v[152:153] offset:5152
    ds_write_b32 v88, v154 offset:5152
    ds_write_b64 v87, v[156:157] offset:5792
    ds_write_b32 v88, v158 offset:5792
    v_mov_b32 v9, 2
    ds_write_b32 v15, v9 offset:32
    buffer_load_dwordx4 v[160:163], v92, s[24:27], 0 offen sc1
    s_waitcnt vmcnt(1)
Lc13:
    v_cmpx_eq_u32 vcc, s32, v19
    v_cmpx_eq_u32 vcc, s32, v23
    v_cmpx_eq_u32 vcc, s32, v27
    v_cmpx_eq_u32 vcc, s32, v31
    v_cmpx_eq_u32 vcc, s32, v35
    v_cmpx_eq_u32 vcc, s32, v39
    v_cmpx_eq_u32 vcc, s32, v43
    v_cmpx_eq_u32 vcc, s32, v47
    v_cmpx_eq_u32 vcc, s32, v51
    v_cmpx_eq_u32 vcc, s32, v55
    v_cmpx_eq_u32 vcc, s32, v59
    v_cmpx_eq_u32 vcc, s32, v63
    v_cmpx_eq_u32 vcc, s32, v67
    v_cmpx_eq_u32 vcc, s32, v71
    v_cmpx_eq_u32 vcc, s32, v75
    v_cmpx_eq_u32 vcc, s32, v79
    s_cmp_eq_u64 exec, -1
    s_mov_b64 exec, -1
    s_cbranch_scc1 Lcd14
    s_sub_u32 s92, s92, 1
    s_cbranch_scc1 Lcd14
    s_xor_b32 s44, s4, 2
    s_lshl_b32 s44, s44, 13
    s_xor_b32 s45, s44, 0x2000
    buffer_load_dwordx4 v[16:19], v1, s[24:27], s44 offen offset:0 sc1
    buffer_load_dwordx4 v[20:23], v1, s[24:27], s44 offen offset:1024 sc1
    buffer_load_dwordx4 v[24:27], v1, s[24:27], s44 offen offset:2048 sc1
    buffer_load_dwordx4 v[28:31], v1, s[24:27], s44 offen offset:3072 sc1
    buffer_load_dwordx4 v[32:35], v12, s[24:27], s44 offen offset:0 sc1
    buffer_load_dwordx4 v[36:39], v12, s[24:27], s44 offen offset:1024 sc1
    buffer_load_dwordx4 v[40:43], v12, s[24:27], s44 offen offset:2048 sc1
    buffer_load_dwordx4 v[44:47], v12, s[24:27], s44 offen offset:3072 sc1
    buffer_load_dwordx4 v[48:51], v1, s[24:27], s45 offen offset:0 sc1
    buffer_load_dwordx4 v[52:55], v1, s[24:27], s45 offen offset:1024 sc1
    buffer_load_dwordx4 v[56:59], v1, s[24:27], s45 offen offset:2048 sc1
    buffer_load_dwordx4 v[60:63], v1, s[24:27], s45 offen offset:3072 sc1
    buffer_load_dwordx4 v[64:67], v12, s[24:27], s45 offen offset:0 sc1
    buffer_load_dwordx4 v[68:71], v12, s[24:27], s45 offen offset:1024 sc1
    buffer_load_dwordx4 v[72:75], v12, s[24:27], s45 offen offset:2048 sc1
    buffer_load_dwordx4 v[76:79], v12, s[24:27], s45 offen offset:3072 sc1
    s_waitcnt vmcnt(0)
    s_branch Lc13
Lcd14:
    ds_write_b64 v85, v[16:17] offset:7728
    ds_write_b32 v86, v18 offset:7728
    ds_write_b64 v85, v[20:21] offset:7984
    ds_write_b32 v165, v22 offset:7728
    ds_write_b64 v85, v[24:25] offset:10304
    ds_write_b32 v86, v26 offset:10304
    ds_write_b64 v85, v[28:29] offset:10560
    ds_write_b32 v165, v30 offset:10304
    ds_write_b64 v87, v[32:33] offset:7728
    ds_write_b32 v88, v34 offset:7728
    ds_write_b64 v87, v[36:37] offset:8368
    ds_write_b32 v88, v38 offset:8368
    ds_write_b64 v87, v[40:41] offset:10304
    ds_write_b32 v88, v42 offset:10304
    ds_write_b64 v87, v[44:45] offset:10944
    ds_write_b32 v88, v46 offset:10944
    ds_write_b64 v85, v[48:49] offset:12880
    ds_write_b32 v86, v50 offset:12880
    ds_write_b64 v85, v[52:53] offset:13136
    ds_write_b32 v165, v54 offset:12880
    ds_write_b64 v85, v[56:57] offset:15456
    ds_write_b32 v86, v58 offset:15456
    ds_write_b64 v85, v[60:61] offset:15712
    ds_write_b32 v165, v62 offset:15456
    ds_write_b64 v87, v[64:65] offset:12880
    ds_write_b32 v88, v66 offset:12880
    ds_write_b64 v87, v[68:69] offset:13520
    ds_write_b32 v88, v70 offset:13520
    ds_write_b64 v87, v[72:73] offset:15456
    ds_write_b32 v88, v74 offset:15456
    ds_write_b64 v87, v[76:77] offset:16096
    ds_write_b32 v88, v78 offset:16096
    v_mov_b32 v9, 4
    ds_write_b32 v15, v9 offset:32
    s_waitcnt vmcnt(0)
    v_xor_b32 v160, s32, v160
    v_xor_b32 v161, s32, v161
    v_xor_b32 v162, s32, v162
    v_xor_b32 v163, s32, v163
    v_or3_b32 v160, v160, v161, v162
    v_or_b32 v160, v160, v163
    v_cmp_ne_u32 vcc, 0, v160
    s_ff1_i32_b64 s58, vcc
    s_lshr_b32 s58, s58, 1
Lkv_loop:
    s_add_u32 s59, s56, 2
Lkv_need:
    s_cmp_ge_u32 s58, s59
    s_cbranch_scc1 Lkv_have
    s_sub_u32 s92, s92, 1
    s_cbranch_scc1 Lkv_have
    buffer_load_dwordx4 v[160:163], v92, s[24:27], 0 offen sc1
    v_mov_b32 v9, s56
    s_waitcnt vmcnt(1)
    ds_write_b32 v15, v9 offset:32
    s_waitcnt vmcnt(0)
    v_xor_b32 v160, s32, v160
    v_xor_b32 v161, s32, v161
    v_xor_b32 v162, s32, v162
    v_xor_b32 v163, s32, v163
    v_or3_b32 v160, v160, v161, v162
    v_or_b32 v160, v160, v163
    v_cmp_ne_u32 vcc, 0, v160
    s_ff1_i32_b64 s58, vcc
    s_lshr_b32 s58, s58, 1
    s_cmp_ge_u32 s58, s59
    s_cbranch_scc1 Lkv_have
    s_sleep 4
    s_branch Lkv_need
Lkv_have:
    s_and_b32 s44, s56, 0x17
    s_cmp_lg_u32 s44, 6
    s_cbranch_scc1 Lkv_noq
    s_cmp_eq_u32 s56, 6
    s_cselect_b32 s44, 12, 24
    v_add_u32 v10, s44, v15
Lw15:
    ds_read_b32 v13, v10 offset:0
    s_waitcnt lgkmcnt(0)
    v_readfirstlane_b32 s44, v13
    s_cmp_ge_u32 s44, 8
    s_cbranch_scc1 Lwd16
    s_sub_u32 s92, s92, 1
    s_cbranch_scc1 Lwd16
    s_sleep 1
    s_branch Lw15
Lwd16:
    s_mov_b32 exec_lo, 0xf0000000
    s_cmp_eq_u32 s56, 6
    s_cselect_b32 exec_lo, 0x0fffc000, exec_lo
    s_cselect_b32 exec_hi, 0, 0x7fffffff
    ds_write_b128 v84, v[80:83] offset:2560
    s_mov_b64 exec, -1
Lkv_noq:
    s_bitcmp1_b32 1145044992, s56
    s_cbranch_scc1 Lwc
Lwc_ret:
    s_sub_u32 s59, s56, 2
    s_max_i32 s59, s59, 8
    s_min_i32 s59, s59, s56
    v_mov_b32 v9, s59
    s_xor_b32 s44, s4, s56
    s_mul_i32 s44, s44, 5120
    s_add_u32 s44, s44, 327680
    s_mov_b32 m0, s57
    s_add_u32 s57, s57, 2576
    buffer_load_dwordx4 v1, s[24:27], s44 offen lds
    buffer_load_dwordx4 v1, s[24:27], s44 offen offset:1024 lds
    s_mov_b32 exec_hi, 0
    buffer_load_dwordx4 v1, s[24:27], s44 offen offset:2048 lds
    s_mov_b32 exec_hi, -1
    s_add_u32 s44, s44, 2560
    s_mov_b32 m0, s57
    s_add_u32 s57, s57, 2576
    buffer_load_dwordx4 v1, s[24:27], s44 offen lds
    buffer_load_dwordx4 v1, s[24:27], s44 offen offset:1024 lds
    s_mov_b32 exec_hi, 0
    buffer_load_dwordx4 v1, s[24:27], s44 offen offset:2048 lds
    s_mov_b32 exec_hi, -1
    s_add_u32 s56, s56, 1
    s_xor_b32 s44, s4, s56
    s_mul_i32 s44, s44, 5120
    s_add_u32 s44, s44, 327680
    s_mov_b32 m0, s57
    s_add_u32 s57, s57, 2576
    buffer_load_dwordx4 v1, s[24:27], s44 offen lds
    buffer_load_dwordx4 v1, s[24:27], s44 offen offset:1024 lds
    s_mov_b32 exec_hi, 0
    buffer_load_dwordx4 v1, s[24:27], s44 offen offset:2048 lds
    s_mov_b32 exec_hi, -1
    s_add_u32 s44, s44, 2560
    s_mov_b32 m0, s57
    s_add_u32 s57, s57, 2576
    buffer_load_dwordx4 v1, s[24:27], s44 offen lds
    buffer_load_dwordx4 v1, s[24:27], s44 offen offset:1024 lds
    s_mov_b32 exec_hi, 0
    buffer_load_dwordx4 v1, s[24:27], s44 offen offset:2048 lds
    s_mov_b32 exec_hi, -1
    s_add_u32 s56, s56, 1
    s_cmp_gt_u32 s56, 10
    s_cbranch_scc1 Lkv_deep
    s_waitcnt vmcnt(12)
Lkv_deep:
    s_waitcnt vmcnt(24)
    ds_write_b32 v15, v9 offset:32
    s_cmp_lt_u32 s56, 32
    s_cbranch_scc1 Lkv_loop
    v_mov_b32 v160, -1
    v_mov_b32 v161, -1
    v_mov_b32 v162, -1
    v_mov_b32 v163, -1
    s_lshl_b32 s44, s5, 18
    s_lshl_b32 s45, s4, 10
    s_add_u32 s44, s44, s45
    s_add_u32 s44, s44, 16777216
    buffer_store_dwordx4 v[160:163], v1, s[24:27], s44 offen sc1
    s_add_u32 s44, s44, 32768
    buffer_store_dwordx4 v[160:163], v1, s[24:27], s44 offen sc1
    s_add_u32 s44, s44, 32768
    buffer_store_dwordx4 v[160:163], v1, s[24:27], s44 offen sc1
    s_add_u32 s44, s44, 32768
    buffer_store_dwordx4 v[160:163], v1, s[24:27], s44 offen sc1
    s_add_u32 s44, s44, 32768
    buffer_store_dwordx4 v[160:163], v1, s[24:27], s44 offen sc1
    s_add_u32 s44, s44, 32768
    buffer_store_dwordx4 v[160:163], v1, s[24:27], s44 offen sc1
    s_add_u32 s44, s44, 32768
    buffer_store_dwordx4 v[160:163], v1, s[24:27], s44 offen sc1
    s_add_u32 s44, s44, 32768
    buffer_store_dwordx4 v[160:163], v1, s[24:27], s44 offen sc1
    s_lshl_b32 s44, s5, 16
    s_lshl_b32 s45, s4, 9
    s_add_u32 s44, s44, s45
    s_add_u32 s44, s44, 18874368
    v_lshlrev_b32 v6, 3, v0
    buffer_store_dwordx2 v[160:161], v6, s[24:27], s44 offen sc1
    s_add_u32 s44, s44, 16384
    buffer_store_dwordx2 v[160:161], v6, s[24:27], s44 offen sc1
    s_add_u32 s44, s44, 16384
    buffer_store_dwordx2 v[160:161], v6, s[24:27], s44 offen sc1
    s_add_u32 s44, s44, 16384
    buffer_store_dwordx2 v[160:161], v6, s[24:27], s44 offen sc1
    v_mov_b32 v9, 30
    v_add_u32 v9, 2, v9
    s_waitcnt vmcnt(0) lgkmcnt(0)
    ds_write_b32 v15, v9 offset:32
    s_lshl_b32 s44, s4, 10
    s_lshl_b32 s45, s5, 7
    s_add_u32 s44, s44, s45
    s_add_u32 s44, s44, 917504
    v_mov_b32 v4, s44
    s_getreg_b32 s44, hwreg(HW_REG_XCC_ID, 0, 3)
    v_xor_b32 v5, s44, v8
    s_mov_b64 exec, 1
    buffer_store_dword v5, v4, s[24:27], 0 offen sc1
    s_mov_b64 exec, -1
    s_cmp_lg_u32 s2, 0
    s_cbranch_scc1 Lwo
    v_mov_b32 v4, 319488
    s_mov_b64 exec, 1
    buffer_store_dword v8, v4, s[24:27], 0 offen sc1
    s_mov_b64 exec, -1
    s_branch Lwo
Lwc:
    s_cmp_ge_u32 s4, 20
    s_cbranch_scc1 Lwc_ret
    s_cmp_eq_u32 s56, 26
    s_cbranch_scc1 Lwc_b
    s_cmp_eq_u32 s56, 30
    s_cbranch_scc1 Lwc_c
    s_cmp_ge_u32 s4, 10
    s_cselect_b32 s47, 10, 0
    s_cselect_b32 s48, 40, 0
    s_sub_u32 s47, s4, s47
    s_add_u32 s49, s47, s5
    s_add_u32 s49, s49, 1
    s_and_b32 s49, s49, 7
    s_mul_i32 s49, s49, 80
    s_cmp_lt_u32 s5, 4
    s_cselect_b32 s60, 1, 0
    s_xor_b32 s60, s60, s47
    s_mul_i32 s60, s60, 320
    s_sub_u32 s60, s60, 2544
    s_cmp_lt_u32 s47, 8
    s_cselect_b32 s49, s49, s60
    s_cselect_b32 s60, 4, 2
    s_cselect_b32 s61, 4, 16
    s_cselect_b32 s62, 0, 40
    s_add_u32 s49, s49, s48
    s_mul_i32 s49, s49, 1280
    s_mul_i32 s45, s5, 160
    s_add_u32 s49, s49, s45
    s_movk_i32 s47, 205
    s_movk_i32 s46, 1280
    v_add_u32 v10, 0, v0
    v_mul_u32_u24 v11, s47, v10
    v_lshrrev_b32 v11, 11, v11
    v_mul_u32_u24 v6, 10, v11
    v_sub_u32 v6, v10, v6
    v_and_b32 v13, 8, v11
    v_lshrrev_b32 v13, 1, v13
    v_xor_b32 v11, v11, v13
    v_lshlrev_b32 v6, 4, v6
    v_lshrrev_b32 v13, s60, v11
    v_mad_u32_u24 v12, v13, s61, v11
    v_lshrrev_b32 v13, 3, v11
    v_mad_u32_u24 v12, v13, s62, v12
    s_mov_b32 m0, 148480
    v_mad_u32_u24 v12, v12, s46, v6
    buffer_load_dwordx4 v12, s[20:23], s49 offen lds
    v_add_u32 v10, 64, v0
    v_mul_u32_u24 v11, s47, v10
    v_lshrrev_b32 v11, 11, v11
    v_mul_u32_u24 v6, 10, v11
    v_sub_u32 v6, v10, v6
    v_and_b32 v13, 8, v11
    v_lshrrev_b32 v13, 1, v13
    v_xor_b32 v11, v11, v13
    v_lshlrev_b32 v6, 4, v6
    v_lshrrev_b32 v13, s60, v11
    v_mad_u32_u24 v12, v13, s61, v11
    v_lshrrev_b32 v13, 3, v11
    v_mad_u32_u24 v12, v13, s62, v12
    s_mov_b32 m0, 149504
    v_mad_u32_u24 v12, v12, s46, v6
    buffer_load_dwordx4 v12, s[20:23], s49 offen lds
    v_add_u32 v10, 128, v0
    v_mul_u32_u24 v11, s47, v10
    v_lshrrev_b32 v11, 11, v11
    v_mul_u32_u24 v6, 10, v11
    v_sub_u32 v6, v10, v6
    v_and_b32 v13, 8, v11
    v_lshrrev_b32 v13, 1, v13
    v_xor_b32 v11, v11, v13
    v_lshlrev_b32 v6, 4, v6
    v_lshrrev_b32 v13, s60, v11
    v_mad_u32_u24 v12, v13, s61, v11
    v_lshrrev_b32 v13, 3, v11
    v_mad_u32_u24 v12, v13, s62, v12
    s_mov_b32 m0, 150528
    v_mad_u32_u24 v12, v12, s46, v6
    buffer_load_dwordx4 v12, s[20:23], s49 offen lds
    v_add_u32 v10, 192, v0
    v_mul_u32_u24 v11, s47, v10
    v_lshrrev_b32 v11, 11, v11
    v_mul_u32_u24 v6, 10, v11
    v_sub_u32 v6, v10, v6
    v_and_b32 v13, 8, v11
    v_lshrrev_b32 v13, 1, v13
    v_xor_b32 v11, v11, v13
    v_lshlrev_b32 v6, 4, v6
    v_lshrrev_b32 v13, s60, v11
    v_mad_u32_u24 v12, v13, s61, v11
    v_lshrrev_b32 v13, 3, v11
    v_mad_u32_u24 v12, v13, s62, v12
    s_mov_b32 m0, 151552
    v_mad_u32_u24 v12, v12, s46, v6
    buffer_load_dwordx4 v12, s[20:23], s49 offen lds
    v_add_u32 v10, 256, v0
    v_mul_u32_u24 v11, s47, v10
    v_lshrrev_b32 v11, 11, v11
    v_mul_u32_u24 v6, 10, v11
    v_sub_u32 v6, v10, v6
    v_and_b32 v13, 8, v11
    v_lshrrev_b32 v13, 1, v13
    v_xor_b32 v11, v11, v13
    v_lshlrev_b32 v6, 4, v6
    v_lshrrev_b32 v13, s60, v11
    v_mad_u32_u24 v12, v13, s61, v11
    v_lshrrev_b32 v13, 3, v11
    v_mad_u32_u24 v12, v13, s62, v12
    s_mov_b32 m0, 152576
    v_mad_u32_u24 v12, v12, s46, v6
    buffer_load_dwordx4 v12, s[20:23], s49 offen lds
    s_branch Lwc_ret
Lwc_b:
    v_lshrrev_b32 v12, 4, v0
    v_bfe_u32 v13, v0, 2, 2
    v_lshl_add_u32 v13, v12, 3, v13
    v_and_b32 v10, 1, v12
    v_lshl_add_u32 v13, v10, 2, v13
    v_xor_b32 v10, 4, v13
    v_and_b32 v11, 3, v0
    v_mul_u32_u24 v11, 40, v11
    v_add_u32 v11, 148480, v11
    s_movk_i32 s44, 160
    v_mad_u32_u24 v2, v13, s44, v11
    v_mad_u32_u24 v3, v10, s44, v11
    s_mul_i32 s44, s5, 20
    s_add_u32 s44, s44, s4
    s_mul_i32 s45, s44, 5120
    s_add_u32 s45, s45, 14680064
    s_add_u32 s47, s45, 4096
    s_lshl_b32 s44, s44, 7
    s_add_u32 s44, s44, 950272
    v_mov_b32 v4, s44
    ds_read_b64_tr_b16 v[16:17], v2 offset:0
    ds_read_b64_tr_b16 v[18:19], v3 offset:0
    ds_read_b64_tr_b16 v[20:21], v2 offset:8
    ds_read_b64_tr_b16 v[22:23], v3 offset:8
    ds_read_b64_tr_b16 v[24:25], v2 offset:16
    ds_read_b64_tr_b16 v[26:27], v3 offset:16
    ds_read_b64_tr_b16 v[28:29], v2 offset:24
    ds_read_b64_tr_b16 v[30:31], v3 offset:24
    ds_read_b64_tr_b16 v[32:33], v2 offset:32
    ds_read_b64_tr_b16 v[34:35], v3 offset:32
    s_waitcnt lgkmcnt(8)
    buffer_store_dwordx4 v[16:19], v1, s[24:27], s45 offen offset:0 sc1
    s_waitcnt lgkmcnt(6)
    buffer_store_dwordx4 v[20:23], v1, s[24:27], s45 offen offset:1024 sc1
    s_waitcnt lgkmcnt(4)
    buffer_store_dwordx4 v[24:27], v1, s[24:27], s45 offen offset:2048 sc1
    s_waitcnt lgkmcnt(2)
    buffer_store_dwordx4 v[28:31], v1, s[24:27], s45 offen offset:3072 sc1
    s_waitcnt lgkmcnt(0)
    buffer_store_dwordx4 v[32:35], v1, s[24:27], s47 offen offset:0 sc1
    s_branch Lwc_ret
Lwc_c:
    s_mov_b64 exec, 1
    buffer_store_dword v8, v4, s[24:27], 0 offen sc1
    s_mov_b32 exec_lo, 0
    s_mov_b32 exec_hi, 100663296
    ds_write_b128 v84, v[80:83] offset:2560
    s_mov_b64 exec, -1
    s_branch Lwc_ret
Lkvp2:
    v_and_b32 v12, 15, v0
    v_lshlrev_b32 v12, 4, v12
    v_lshl_add_u32 v12, v11, 2, v12
    v_lshlrev_b32 v5, 3, v11
    v_bfe_u32 v13, v0, 2, 2
    v_add_u32 v5, v5, v13
    v_mul_u32_u24 v5, 40, v5
    v_and_b32 v13, 3, v0
    v_lshlrev_b32 v13, 3, v13
    v_add3_u32 v5, v5, v13, s55
    s_mul_i32 s44, s3, 3072
    s_add_u32 s44, s44, 136192
    v_add_u32 v6, s44, v1
    v_and_b32 v88, 15, v0
    v_lshrrev_b32 v89, 5, v0
    v_lshrrev_b32 v90, 2, v88
    v_xor_b32 v89, v89, v90
    v_lshl_add_u32 v88, v88, 2, v89
    v_bfe_u32 v89, v0, 4, 1
    v_lshlrev_b32 v89, 11, v89
    v_lshl_add_u32 v88, v88, 4, v89
    s_bfe_u32 s44, s3, 0x10001
    s_lshl_b32 s44, s44, 12
    v_add_u32 v116, s44, v88
    v_xor_b32 v117, 32, v116
    v_lshrrev_b32 v88, 5, v0
    v_lshlrev_b32 v88, 3, v88
    v_bfe_u32 v89, v0, 2, 2
    v_lshl_add_u32 v88, v89, 1, v88
    v_mul_u32_u24 v88, 160, v88
    v_bfe_u32 v89, v0, 4, 1
    v_lshl_add_u32 v88, v89, 5, v88
    v_and_b32 v89, 3, v0
    v_lshl_add_u32 v88, v89, 3, v88
    s_lshr_b32 s44, s3, 2
    s_and_b32 s99, s3, 1
    s_lshl1_add_u32 s99, s44, s99
    s_mul_i32 s44, s99, 40
    s_add_u32 s44, s44, 8192
    v_add_u32 v118, s44, v88
    v_add_u32 v119, 55296, v116
    v_add_u32 v120, 55296, v117
    v_add_u32 v121, 55296, v118
    v_add_u32 v122, 110592, v116
    v_add_u32 v123, 110592, v117
    v_add_u32 v124, 110592, v118
    v_lshlrev_b32 v156, 4, v0
    v_bfe_u32 v88, v0, 4, 1
    v_lshrrev_b32 v89, 5, v0
    v_xor_b32 v89, v89, v88
    v_lshl_add_u32 v89, v88, 1, v89
    v_and_b32 v88, 15, v0
    v_lshl_add_u32 v89, v89, 4, v88
    v_lshlrev_b32 v157, 2, v89
    v_add_u32 v157, 1024, v157
    v_and_b32 v88, 31, v0
    v_lshrrev_b32 v89, 5, v0
    v_mul_u32_u24 v89, 20, v89
    v_add_u32 v89, v88, v89
    v_lshlrev_b32 v89, 4, v89
    v_add_u32 v89, 1280, v89
    v_cmp_eq_u32 vcc, 20, v88
    v_mov_b32 v90, 1073741824
    v_mov_b32 v91, 2560
    v_mov_b32 v92, 0x3F803F80
    v_mov_b32 v93, 0
    v_cndmask_b32 v90, v90, v91, vcc
    v_cndmask_b32 v144, v93, v92, vcc
    v_cndmask_b32 v145, v93, v92, vcc
    v_cndmask_b32 v146, v93, v92, vcc
    v_cndmask_b32 v147, v93, v92, vcc
    v_cndmask_b32 v148, v93, v92, vcc
    v_cndmask_b32 v149, v93, v92, vcc
    v_cndmask_b32 v150, v93, v92, vcc
    v_cndmask_b32 v151, v93, v92, vcc
    v_cmp_gt_u32 vcc, 20, v88
    v_add_u32 v91, 640, v89
    s_nop 0
    v_cndmask_b32 v158, v90, v89, vcc
    v_cndmask_b32 v159, v90, v91, vcc
    v_cmp_gt_u32 vcc, 32, v0
    v_mov_b32 v88, 0x3F80
    v_mov_b32 v155, 0
    v_cndmask_b32 v153, v155, v88, vcc
    v_add_u32 v162, 157136, v156
    v_add_u32 v163, 157136, v157
    v_add_u32 v164, 157136, v158
    v_add_u32 v165, 157136, v159
    v_and_b32 v88, 31, v0
    s_bfe_u32 s44, s3, 0x10001
    s_lshl_b32 s44, s44, 7
    s_add_u32 s44, s44, 162544
    v_lshl_add_u32 v125, v88, 2, s44
    s_lshl_b32 s48, s4, 13
    s_lshl_b32 s45, s5, 10
    s_add_u32 s48, s48, s45
    v_and_b32 v10, 3, v0
    v_cmp_eq_u32 s[50:51], 1, v10
    v_cmp_eq_u32 s[52:53], 2, v10
    v_cmp_eq_u32 s[54:55], 3, v10
    v_and_b32 v10, 8, v0
    v_cmp_eq_u32 s[56:57], 8, v10
    s_lshl_b32 s49, s4, 1
    s_bfe_u32 s45, s5, 0x10001
    s_add_u32 s49, s49, s45
    s_mul_i32 s49, s49, 2560
    s_add_u32 s49, s49, 327680
    s_and_b32 s45, s5, 1
    v_and_b32 v10, 15, v0
    v_bfe_u32 v11, v0, 4, 1
    v_xor_b32 v3, s45, v11
    v_lshl_add_u32 v3, v3, 4, v10
    s_lshl_b32 s47, s45, 7
    v_lshl_add_u32 v3, v3, 2, s47
    s_cmp_ge_u32 s5, 4
    s_cselect_b32 s47, 20, 32
    s_cselect_b32 s44, 40, 16
    s_mul_i32 s44, s44, s45
    v_mad_u32_u24 v2, v11, s47, v10
    v_add_u32 v2, s44, v2
    v_lshlrev_b32 v2, 4, v2
    s_lshl_b32 s44, s4, 7
    s_lshl_b32 s45, s5, 2
    s_add_u32 s44, s44, s45
    s_add_u32 s44, s44, 262144
    v_mov_b32 v4, s44
    s_mov_b32 s45, 0xbfb8aa3b
    s_waitcnt vmcnt(13)
    ds_bpermute_b32 v16, v12, v96
    ds_bpermute_b32 v17, v12, v97
    ds_bpermute_b32 v18, v12, v98
    ds_bpermute_b32 v19, v12, v99
    ds_bpermute_b32 v20, v12, v100
    ds_bpermute_b32 v21, v12, v101
    ds_bpermute_b32 v22, v12, v102
    ds_bpermute_b32 v23, v12, v103
    ds_bpermute_b32 v24, v12, v104
    ds_bpermute_b32 v25, v12, v105
    ds_bpermute_b32 v26, v12, v106
    ds_bpermute_b32 v27, v12, v107
    ds_bpermute_b32 v28, v12, v108
    ds_bpermute_b32 v29, v12, v109
    ds_bpermute_b32 v30, v12, v110
    ds_bpermute_b32 v31, v12, v111
    ds_bpermute_b32 v32, v12, v112
    ds_bpermute_b32 v33, v12, v113
    ds_bpermute_b32 v34, v12, v114
    ds_bpermute_b32 v35, v12, v115
    s_waitcnt vmcnt(1)
    s_cmp_ge_u32 s5, 4
    s_cbranch_scc1 Lh_vtype
    ds_read_b64_tr_b16 v[56:57], v5 offset:0
    ds_read_b64_tr_b16 v[58:59], v5 offset:160
    ds_read_b64_tr_b16 v[60:61], v5 offset:32
    ds_read_b64_tr_b16 v[62:63], v5 offset:192
    ds_read_b64_tr_b16 v[64:65], v5 offset:1280
    ds_read_b64_tr_b16 v[66:67], v5 offset:1440
    ds_read_b64_tr_b16 v[68:69], v5 offset:1312
    ds_read_b64_tr_b16 v[70:71], v5 offset:1472
    s_waitcnt lgkmcnt(4)
    v_mfma_f32_16x16x32_bf16 v[72:75], v[56:59], v[16:19], 0
    v_mfma_f32_16x16x32_bf16 v[76:79], v[60:63], v[16:19], 0
    ds_read_b64_tr_b16 v[56:57], v5 offset:2560
    ds_read_b64_tr_b16 v[58:59], v5 offset:2720
    ds_read_b64_tr_b16 v[60:61], v5 offset:2592
    ds_read_b64_tr_b16 v[62:63], v5 offset:2752
    s_waitcnt lgkmcnt(4)
    v_mfma_f32_16x16x32_bf16 v[72:75], v[64:67], v[20:23], v[72:75]
    v_mfma_f32_16x16x32_bf16 v[76:79], v[68:71], v[20:23], v[76:79]
    ds_read_b64_tr_b16 v[64:65], v5 offset:3840
    ds_read_b64_tr_b16 v[66:67], v5 offset:4000
    ds_read_b64_tr_b16 v[68:69], v5 offset:3872
    ds_read_b64_tr_b16 v[70:71], v5 offset:4032
    s_waitcnt lgkmcnt(4)
    v_mfma_f32_16x16x32_bf16 v[72:75], v[56:59], v[24:27], v[72:75]
    v_mfma_f32_16x16x32_bf16 v[76:79], v[60:63], v[24:27], v[76:79]
    ds_read_b64_tr_b16 v[56:57], v5 offset:5120
    ds_read_b64_tr_b16 v[58:59], v5 offset:5280
    ds_read_b64_tr_b16 v[60:61], v5 offset:5152
    ds_read_b64_tr_b16 v[62:63], v5 offset:5312
    s_waitcnt lgkmcnt(4)
    v_mfma_f32_16x16x32_bf16 v[72:75], v[64:67], v[28:31], v[72:75]
    v_mfma_f32_16x16x32_bf16 v[76:79], v[68:71], v[28:31], v[76:79]
    s_waitcnt lgkmcnt(0)
    v_mfma_f32_16x16x32_bf16 v[72:75], v[56:59], v[32:35], v[72:75]
    v_mfma_f32_16x16x32_bf16 v[76:79], v[60:63], v[32:35], v[76:79]
    s_branch Lh_part
Lh_vtype:
    ds_read_b64_tr_b16 v[56:57], v5 offset:0
    ds_read_b64_tr_b16 v[58:59], v5 offset:160
    ds_read_b64_tr_b16 v[60:61], v5 offset:32
    ds_read_b64_tr_b16 v[62:63], v5 offset:192
    ds_read_b64_tr_b16 v[64:65], v5 offset:1280
    ds_read_b64_tr_b16 v[66:67], v5 offset:1440
    ds_read_b64_tr_b16 v[68:69], v5 offset:1312
    ds_read_b64_tr_b16 v[70:71], v5 offset:1472
    s_waitcnt lgkmcnt(4)
    v_mfma_f32_16x16x32_bf16 v[72:75], v[16:19], v[56:59], 0
    v_mfma_f32_16x16x32_bf16 v[76:79], v[16:19], v[60:63], 0
    v_mfma_f32_16x16x32_bf16 v[80:83], v[16:19], v[36:39], 0
    ds_read_b64_tr_b16 v[56:57], v5 offset:2560
    ds_read_b64_tr_b16 v[58:59], v5 offset:2720
    ds_read_b64_tr_b16 v[60:61], v5 offset:2592
    ds_read_b64_tr_b16 v[62:63], v5 offset:2752
    s_waitcnt lgkmcnt(4)
    v_mfma_f32_16x16x32_bf16 v[72:75], v[20:23], v[64:67], v[72:75]
    v_mfma_f32_16x16x32_bf16 v[76:79], v[20:23], v[68:71], v[76:79]
    v_mfma_f32_16x16x32_bf16 v[80:83], v[20:23], v[40:43], v[80:83]
    ds_read_b64_tr_b16 v[64:65], v5 offset:3840
    ds_read_b64_tr_b16 v[66:67], v5 offset:4000
    ds_read_b64_tr_b16 v[68:69], v5 offset:3872
    ds_read_b64_tr_b16 v[70:71], v5 offset:4032
    s_waitcnt lgkmcnt(4)
    v_mfma_f32_16x16x32_bf16 v[72:75], v[24:27], v[56:59], v[72:75]
    v_mfma_f32_16x16x32_bf16 v[76:79], v[24:27], v[60:63], v[76:79]
    v_mfma_f32_16x16x32_bf16 v[80:83], v[24:27], v[44:47], v[80:83]
    ds_read_b64_tr_b16 v[56:57], v5 offset:5120
    ds_read_b64_tr_b16 v[58:59], v5 offset:5280
    ds_read_b64_tr_b16 v[60:61], v5 offset:5152
    ds_read_b64_tr_b16 v[62:63], v5 offset:5312
    s_waitcnt lgkmcnt(4)
    v_mfma_f32_16x16x32_bf16 v[72:75], v[28:31], v[64:67], v[72:75]
    v_mfma_f32_16x16x32_bf16 v[76:79], v[28:31], v[68:71], v[76:79]
    v_mfma_f32_16x16x32_bf16 v[80:83], v[28:31], v[48:51], v[80:83]
    s_waitcnt lgkmcnt(0)
    v_mfma_f32_16x16x32_bf16 v[72:75], v[32:35], v[56:59], v[72:75]
    v_mfma_f32_16x16x32_bf16 v[76:79], v[32:35], v[60:63], v[76:79]
    v_mfma_f32_16x16x32_bf16 v[80:83], v[32:35], v[52:55], v[80:83]
Lh_part:
    s_cmp_eq_u32 s3, 0
    s_cbranch_scc1 Lred
    s_nop 5
    ds_write_b128 v6, v[72:75] offset:0
    ds_write_b128 v6, v[76:79] offset:1024
    ds_write_b128 v6, v[80:83] offset:2048
    s_waitcnt lgkmcnt(0)
    s_mov_b64 exec, 1
    ds_add_u32 v15, v14 offset:0
    s_mov_b64 exec, -1
    s_setprio 0
    s_branch Lq
Lred:
    s_waitcnt vmcnt(0)
    v_readfirstlane_b32 s32, v9
    s_add_u32 s32, s32, 2654435768
    s_or_b32 s32, s32, 1
    v_mov_b32 v87, s32
    ds_write_b32 v15, v87 offset:40
Lw17:
    ds_read_b32 v13, v15 offset:0
    s_waitcnt lgkmcnt(0)
    v_readfirstlane_b32 s44, v13
    s_cmp_ge_u32 s44, 3
    s_cbranch_scc1 Lwd18
    s_sub_u32 s92, s92, 1
    s_cbranch_scc1 Lwd18
    s_branch Lw17
Lwd18:
    ds_read_b128 v[16:19], v6 offset:3072
    ds_read_b128 v[20:23], v6 offset:4096
    ds_read_b128 v[24:27], v6 offset:5120
    ds_read_b128 v[28:31], v6 offset:6144
    ds_read_b128 v[32:35], v6 offset:7168
    ds_read_b128 v[36:39], v6 offset:8192
    ds_read_b128 v[40:43], v6 offset:9216
    ds_read_b128 v[44:47], v6 offset:10240
    ds_read_b128 v[48:51], v6 offset:11264
    s_waitcnt lgkmcnt(6)
    v_add_f32 v72, v72, v16
    v_add_f32 v73, v73, v17
    v_add_f32 v74, v74, v18
    v_add_f32 v75, v75, v19
    v_add_f32 v76, v76, v20
    v_add_f32 v77, v77, v21
    v_add_f32 v78, v78, v22
    v_add_f32 v79, v79, v23
    v_add_f32 v80, v80, v24
    v_add_f32 v81, v81, v25
    v_add_f32 v82, v82, v26
    v_add_f32 v83, v83, v27
    s_waitcnt lgkmcnt(0)
    ds_write_b32 v15, v14 offset:16
    v_add_f32 v28, v28, v40
    v_add_f32 v29, v29, v41
    v_add_f32 v30, v30, v42
    v_add_f32 v31, v31, v43
    v_add_f32 v32, v32, v44
    v_add_f32 v33, v33, v45
    v_add_f32 v34, v34, v46
    v_add_f32 v35, v35, v47
    v_add_f32 v36, v36, v48
    v_add_f32 v37, v37, v49
    v_add_f32 v38, v38, v50
    v_add_f32 v39, v39, v51
    v_add_f32 v72, v72, v28
    v_add_f32 v73, v73, v29
    v_add_f32 v74, v74, v30
    v_add_f32 v75, v75, v31
    v_add_f32 v76, v76, v32
    v_add_f32 v77, v77, v33
    v_add_f32 v78, v78, v34
    v_add_f32 v79, v79, v35
    v_add_f32 v80, v80, v36
    v_add_f32 v81, v81, v37
    v_add_f32 v82, v82, v38
    v_add_f32 v83, v83, v39
    v_cvt_pk_bf16_f32 v86, v76, v77
    v_cvt_pk_bf16_f32 v104, v78, v79
    v_cvt_pk_bf16_f32 v84, v72, v73
    v_cvt_pk_bf16_f32 v85, v74, v75
    v_mov_b32 v108, v84
    v_mov_b32 v109, v85
    v_mov_b32 v110, v84
    v_mov_b32 v111, v85
    s_cmp_ge_u32 s5, 4
    s_cbranch_scc1 Lred_v
    v_permlane16_swap_b32 v86, v104
    v_permlane32_swap_b32 v108, v110
    v_permlane32_swap_b32 v109, v111
    buffer_store_dwordx4 v[84:87], v1, s[24:27], s48 offen sc1
    s_mov_b32 exec_hi, 0
    buffer_store_dwordx4 v[108:111], v2, s[24:27], s49 offen sc1
    buffer_store_dword v86, v3, s[24:27], s49 offen offset:1024 sc1
    s_branch Lred_st
Lred_v:
    v_cndmask_b32 v80, v80, v81, s[50:51]
    v_cndmask_b32 v80, v80, v82, s[52:53]
    v_cndmask_b32 v80, v80, v83, s[54:55]
    v_mul_f32 v80, s45, v80
    v_mov_b32 v112, v86
    v_exp_f32 v80, v80
    v_mov_b32 v113, v104
    v_mov_b32 v114, v86
    v_mov_b32 v115, v104
    v_add_f32 v80, 1.0, v80
    v_mov_b32_dpp v86, v104 row_shr:4 row_mask:0xf bank_mask:0x2
    v_rcp_f32 v80, v80
    v_permlane32_swap_b32 v108, v110
    v_cndmask_b32 v86, v86, v80, s[56:57]
    v_permlane32_swap_b32 v109, v111
    buffer_store_dwordx4 v[84:87], v1, s[24:27], s48 offen sc1
    v_permlane32_swap_b32 v112, v114
    v_permlane32_swap_b32 v113, v115
    s_mov_b32 exec_hi, 0
    buffer_store_dwordx4 v[108:111], v2, s[24:27], s49 offen offset:1280 sc1
    s_mov_b32 exec_lo, 0x000f000f
    buffer_store_dwordx4 v[112:115], v2, s[24:27], s49 offen offset:1536 sc1
Lred_st:
    s_mov_b64 exec, -1
    s_setprio 0
    s_branch Lq
Lidle:
    s_cmp_ge_u32 s5, 4
    s_waitcnt lgkmcnt(0)
    s_cselect_b32 s16, s70, s68
    s_cselect_b32 s17, s71, s69
    s_mov_b32 s8, s64
    s_mov_b32 s9, s65
    s_mov_b32 s12, s66
    s_mov_b32 s13, s67
    s_mov_b32 s20, s72
    s_mov_b32 s21, s73
    s_mov_b32 s24, s90
    s_mov_b32 s25, s91
    s_mov_b32 s28, s86
    s_mov_b32 s29, s87
    s_mov_b32 s36, s84
    s_mov_b32 s37, s85
    s_mov_b32 s40, s80
    s_mov_b32 s41, s81
    v_and_b32 v88, 15, v0
    v_lshrrev_b32 v89, 5, v0
    v_lshrrev_b32 v90, 2, v88
    v_xor_b32 v89, v89, v90
    v_lshl_add_u32 v88, v88, 2, v89
    v_bfe_u32 v89, v0, 4, 1
    v_lshlrev_b32 v89, 11, v89
    v_lshl_add_u32 v88, v88, 4, v89
    s_bfe_u32 s44, s3, 0x10001
    s_lshl_b32 s44, s44, 12
    v_add_u32 v116, s44, v88
    v_xor_b32 v117, 32, v116
    v_lshrrev_b32 v88, 5, v0
    v_lshlrev_b32 v88, 3, v88
    v_bfe_u32 v89, v0, 2, 2
    v_lshl_add_u32 v88, v89, 1, v88
    v_mul_u32_u24 v88, 160, v88
    v_bfe_u32 v89, v0, 4, 1
    v_lshl_add_u32 v88, v89, 5, v88
    v_and_b32 v89, 3, v0
    v_lshl_add_u32 v88, v89, 3, v88
    s_lshr_b32 s44, s3, 2
    s_and_b32 s99, s3, 1
    s_lshl1_add_u32 s99, s44, s99
    s_mul_i32 s44, s99, 40
    s_add_u32 s44, s44, 8192
    v_add_u32 v118, s44, v88
    v_add_u32 v119, 55296, v116
    v_add_u32 v120, 55296, v117
    v_add_u32 v121, 55296, v118
    v_add_u32 v122, 110592, v116
    v_add_u32 v123, 110592, v117
    v_add_u32 v124, 110592, v118
    v_lshlrev_b32 v156, 4, v0
    v_bfe_u32 v88, v0, 4, 1
    v_lshrrev_b32 v89, 5, v0
    v_xor_b32 v89, v89, v88
    v_lshl_add_u32 v89, v88, 1, v89
    v_and_b32 v88, 15, v0
    v_lshl_add_u32 v89, v89, 4, v88
    v_lshlrev_b32 v157, 2, v89
    v_add_u32 v157, 1024, v157
    v_and_b32 v88, 31, v0
    v_lshrrev_b32 v89, 5, v0
    v_mul_u32_u24 v89, 20, v89
    v_add_u32 v89, v88, v89
    v_lshlrev_b32 v89, 4, v89
    v_add_u32 v89, 1280, v89
    v_cmp_eq_u32 vcc, 20, v88
    v_mov_b32 v90, 1073741824
    v_mov_b32 v91, 2560
    v_mov_b32 v92, 0x3F803F80
    v_mov_b32 v93, 0
    v_cndmask_b32 v90, v90, v91, vcc
    v_cndmask_b32 v144, v93, v92, vcc
    v_cndmask_b32 v145, v93, v92, vcc
    v_cndmask_b32 v146, v93, v92, vcc
    v_cndmask_b32 v147, v93, v92, vcc
    v_cndmask_b32 v148, v93, v92, vcc
    v_cndmask_b32 v149, v93, v92, vcc
    v_cndmask_b32 v150, v93, v92, vcc
    v_cndmask_b32 v151, v93, v92, vcc
    v_cmp_gt_u32 vcc, 20, v88
    v_add_u32 v91, 640, v89
    s_nop 0
    v_cndmask_b32 v158, v90, v89, vcc
    v_cndmask_b32 v159, v90, v91, vcc
    v_cmp_gt_u32 vcc, 32, v0
    v_mov_b32 v88, 0x3F80
    v_mov_b32 v155, 0
    v_cndmask_b32 v153, v155, v88, vcc
    v_add_u32 v162, 157136, v156
    v_add_u32 v163, 157136, v157
    v_add_u32 v164, 157136, v158
    v_add_u32 v165, 157136, v159
    v_and_b32 v88, 31, v0
    s_bfe_u32 s44, s3, 0x10001
    s_lshl_b32 s44, s44, 7
    s_add_u32 s44, s44, 162544
    v_lshl_add_u32 v125, v88, 2, s44
Lq:
    s_setprio 1
    s_mov_b32 s47, 0
    s_mov_b32 s48, 0
Lq19:
    ds_read_b128 v[80:83], v15 offset:64
    s_waitcnt lgkmcnt(0)
    v_min_u32 v80, v80, v81
    v_min_u32 v82, v82, v83
    v_readfirstlane_b32 s47, v80
    v_readfirstlane_b32 s48, v82
    s_cmp_gt_u32 s47, 0
    s_cbranch_scc1 Lqd20
    s_sub_u32 s92, s92, 1
    s_cbranch_scc1 Lqd20
    s_branch Lq19
Lqd20:
    ds_read_b128 v[16:19], v119 offset:18432
    ds_read_b64_tr_b16 v[20:21], v121 offset:18432
    ds_read_b64_tr_b16 v[22:23], v121 offset:18592
    ds_read_b128 v[24:27], v120 offset:18432
    ds_read_b64_tr_b16 v[28:29], v121 offset:20992
    ds_read_b64_tr_b16 v[30:31], v121 offset:21152
    ds_read_b128 v[32:35], v119 offset:19456
    ds_read_b64_tr_b16 v[36:37], v121 offset:23552
    ds_read_b64_tr_b16 v[38:39], v121 offset:23712
    ds_read_b128 v[40:43], v120 offset:19456
    ds_read_b64_tr_b16 v[44:45], v121 offset:26112
    ds_read_b64_tr_b16 v[46:47], v121 offset:26272
    s_cmp_gt_u32 s48, 0
    s_cbranch_scc1 Lqd22
Lq21:
    ds_read_b128 v[80:83], v15 offset:64
    s_waitcnt lgkmcnt(0)
    v_min_u32 v80, v80, v81
    v_min_u32 v82, v82, v83
    v_readfirstlane_b32 s47, v80
    v_readfirstlane_b32 s48, v82
    s_cmp_gt_u32 s48, 0
    s_cbranch_scc1 Lqd22
    s_sub_u32 s92, s92, 1
    s_cbranch_scc1 Lqd22
    s_branch Lq21
Lqd22:
    ds_read_b128 v[48:51], v119 offset:36864
    ds_read_b64_tr_b16 v[52:53], v121 offset:36864
    ds_read_b64_tr_b16 v[54:55], v121 offset:37024
    ds_read_b128 v[56:59], v120 offset:36864
    ds_read_b64_tr_b16 v[60:61], v121 offset:39424
    ds_read_b64_tr_b16 v[62:63], v121 offset:39584
    ds_read_b128 v[64:67], v119 offset:37888
    ds_read_b64_tr_b16 v[68:69], v121 offset:41984
    ds_read_b64_tr_b16 v[70:71], v121 offset:42144
    ds_read_b128 v[72:75], v120 offset:37888
    ds_read_b64_tr_b16 v[76:77], v121 offset:44544
    ds_read_b64_tr_b16 v[78:79], v121 offset:44704
    s_waitcnt lgkmcnt(15)
    v_mfma_f32_32x32x16_bf16 v[128:143], v[20:23], v[16:19], 0
    s_waitcnt lgkmcnt(15)
    v_mfma_f32_32x32x16_bf16 v[128:143], v[28:31], v[24:27], v[128:143]
    s_waitcnt lgkmcnt(15)
    v_mfma_f32_32x32x16_bf16 v[128:143], v[36:39], v[32:35], v[128:143]
    s_waitcnt lgkmcnt(12)
    v_mfma_f32_32x32x16_bf16 v[128:143], v[44:47], v[40:43], v[128:143]
    s_waitcnt lgkmcnt(9)
    v_mfma_f32_32x32x16_bf16 v[128:143], v[52:55], v[48:51], v[128:143]
    s_waitcnt lgkmcnt(6)
    v_mfma_f32_32x32x16_bf16 v[128:143], v[60:63], v[56:59], v[128:143]
    s_waitcnt lgkmcnt(3)
    v_mfma_f32_32x32x16_bf16 v[128:143], v[68:71], v[64:67], v[128:143]
    s_waitcnt lgkmcnt(0)
    v_mfma_f32_32x32x16_bf16 v[128:143], v[76:79], v[72:75], v[128:143]
    s_mov_b64 exec, 1
    ds_add_u32 v15, v14 offset:4
    s_mov_b64 exec, -1
    s_cmp_lg_u32 s3, 0
    s_cbranch_scc1 Lq_noflag
    s_waitcnt vmcnt(0)
    s_mov_b64 exec, 1
    buffer_store_dword v87, v4, s[24:27], 0 offen sc1
    s_mov_b64 exec, -1
Lq_noflag:
    s_cmp_gt_u32 s47, 1
    s_cbranch_scc1 Lqd24
Lq23:
    ds_read_b128 v[80:83], v15 offset:64
    s_waitcnt lgkmcnt(0)
    v_min_u32 v80, v80, v81
    v_min_u32 v82, v82, v83
    v_readfirstlane_b32 s47, v80
    v_readfirstlane_b32 s48, v82
    s_cmp_gt_u32 s47, 1
    s_cbranch_scc1 Lqd24
    s_sub_u32 s92, s92, 1
    s_cbranch_scc1 Lqd24
    s_branch Lq23
Lqd24:
    ds_read_b128 v[16:19], v116 offset:0
    ds_read_b64_tr_b16 v[20:21], v118 offset:0
    ds_read_b64_tr_b16 v[22:23], v118 offset:160
    ds_read_b128 v[24:27], v117 offset:0
    ds_read_b64_tr_b16 v[28:29], v118 offset:2560
    ds_read_b64_tr_b16 v[30:31], v118 offset:2720
    ds_read_b128 v[32:35], v116 offset:1024
    ds_read_b64_tr_b16 v[36:37], v118 offset:5120
    ds_read_b64_tr_b16 v[38:39], v118 offset:5280
    ds_read_b128 v[40:43], v117 offset:1024
    ds_read_b64_tr_b16 v[44:45], v118 offset:7680
    ds_read_b64_tr_b16 v[46:47], v118 offset:7840
    s_cmp_gt_u32 s48, 1
    s_cbranch_scc1 Lqd26
Lq25:
    ds_read_b128 v[80:83], v15 offset:64
    s_waitcnt lgkmcnt(0)
    v_min_u32 v80, v80, v81
    v_min_u32 v82, v82, v83
    v_readfirstlane_b32 s47, v80
    v_readfirstlane_b32 s48, v82
    s_cmp_gt_u32 s48, 1
    s_cbranch_scc1 Lqd26
    s_sub_u32 s92, s92, 1
    s_cbranch_scc1 Lqd26
    s_branch Lq25
Lqd26:
    ds_read_b128 v[48:51], v116 offset:18432
    ds_read_b64_tr_b16 v[52:53], v118 offset:18432
    ds_read_b64_tr_b16 v[54:55], v118 offset:18592
    ds_read_b128 v[56:59], v117 offset:18432
    ds_read_b64_tr_b16 v[60:61], v118 offset:20992
    ds_read_b64_tr_b16 v[62:63], v118 offset:21152
    ds_read_b128 v[64:67], v116 offset:19456
    ds_read_b64_tr_b16 v[68:69], v118 offset:23552
    ds_read_b64_tr_b16 v[70:71], v118 offset:23712
    ds_read_b128 v[72:75], v117 offset:19456
    ds_read_b64_tr_b16 v[76:77], v118 offset:26112
    ds_read_b64_tr_b16 v[78:79], v118 offset:26272
    s_waitcnt lgkmcnt(15)
    v_mfma_f32_32x32x16_bf16 v[128:143], v[20:23], v[16:19], v[128:143]
    s_waitcnt lgkmcnt(15)
    v_mfma_f32_32x32x16_bf16 v[128:143], v[28:31], v[24:27], v[128:143]
    s_waitcnt lgkmcnt(15)
    v_mfma_f32_32x32x16_bf16 v[128:143], v[36:39], v[32:35], v[128:143]
    s_waitcnt lgkmcnt(12)
    v_mfma_f32_32x32x16_bf16 v[128:143], v[44:47], v[40:43], v[128:143]
    s_waitcnt lgkmcnt(9)
    v_mfma_f32_32x32x16_bf16 v[128:143], v[52:55], v[48:51], v[128:143]
    s_waitcnt lgkmcnt(6)
    v_mfma_f32_32x32x16_bf16 v[128:143], v[60:63], v[56:59], v[128:143]
    s_waitcnt lgkmcnt(3)
    v_mfma_f32_32x32x16_bf16 v[128:143], v[68:71], v[64:67], v[128:143]
    s_waitcnt lgkmcnt(0)
    v_mfma_f32_32x32x16_bf16 v[128:143], v[76:79], v[72:75], v[128:143]
    s_mov_b64 exec, 1
    ds_add_u32 v15, v14 offset:8
    s_mov_b64 exec, -1
    s_cmp_gt_u32 s47, 2
    s_cbranch_scc1 Lqd28
Lq27:
    ds_read_b128 v[80:83], v15 offset:64
    s_waitcnt lgkmcnt(0)
    v_min_u32 v80, v80, v81
    v_min_u32 v82, v82, v83
    v_readfirstlane_b32 s47, v80
    v_readfirstlane_b32 s48, v82
    s_cmp_gt_u32 s47, 2
    s_cbranch_scc1 Lqd28
    s_sub_u32 s92, s92, 1
    s_cbranch_scc1 Lqd28
    s_branch Lq27
Lqd28:
    ds_read_b128 v[16:19], v116 offset:36864
    ds_read_b64_tr_b16 v[20:21], v118 offset:36864
    ds_read_b64_tr_b16 v[22:23], v118 offset:37024
    ds_read_b128 v[24:27], v117 offset:36864
    ds_read_b64_tr_b16 v[28:29], v118 offset:39424
    ds_read_b64_tr_b16 v[30:31], v118 offset:39584
    ds_read_b128 v[32:35], v116 offset:37888
    ds_read_b64_tr_b16 v[36:37], v118 offset:41984
    ds_read_b64_tr_b16 v[38:39], v118 offset:42144
    ds_read_b128 v[40:43], v117 offset:37888
    ds_read_b64_tr_b16 v[44:45], v118 offset:44544
    ds_read_b64_tr_b16 v[46:47], v118 offset:44704
    s_cmp_gt_u32 s48, 2
    s_cbranch_scc1 Lqd30
Lq29:
    ds_read_b128 v[80:83], v15 offset:64
    s_waitcnt lgkmcnt(0)
    v_min_u32 v80, v80, v81
    v_min_u32 v82, v82, v83
    v_readfirstlane_b32 s47, v80
    v_readfirstlane_b32 s48, v82
    s_cmp_gt_u32 s48, 2
    s_cbranch_scc1 Lqd30
    s_sub_u32 s92, s92, 1
    s_cbranch_scc1 Lqd30
    s_branch Lq29
Lqd30:
    ds_read_b128 v[48:51], v119 offset:0
    ds_read_b64_tr_b16 v[52:53], v121 offset:0
    ds_read_b64_tr_b16 v[54:55], v121 offset:160
    ds_read_b128 v[56:59], v120 offset:0
    ds_read_b64_tr_b16 v[60:61], v121 offset:2560
    ds_read_b64_tr_b16 v[62:63], v121 offset:2720
    ds_read_b128 v[64:67], v119 offset:1024
    ds_read_b64_tr_b16 v[68:69], v121 offset:5120
    ds_read_b64_tr_b16 v[70:71], v121 offset:5280
    ds_read_b128 v[72:75], v120 offset:1024
    ds_read_b64_tr_b16 v[76:77], v121 offset:7680
    ds_read_b64_tr_b16 v[78:79], v121 offset:7840
    s_waitcnt lgkmcnt(15)
    v_mfma_f32_32x32x16_bf16 v[128:143], v[20:23], v[16:19], v[128:143]
    s_waitcnt lgkmcnt(15)
    v_mfma_f32_32x32x16_bf16 v[128:143], v[28:31], v[24:27], v[128:143]
    s_waitcnt lgkmcnt(15)
    v_mfma_f32_32x32x16_bf16 v[128:143], v[36:39], v[32:35], v[128:143]
    s_waitcnt lgkmcnt(12)
    v_mfma_f32_32x32x16_bf16 v[128:143], v[44:47], v[40:43], v[128:143]
    ds_read_b128 v[80:83], v15 offset:64
    s_waitcnt lgkmcnt(10)
    v_mfma_f32_32x32x16_bf16 v[128:143], v[52:55], v[48:51], v[128:143]
    s_waitcnt lgkmcnt(7)
    v_mfma_f32_32x32x16_bf16 v[128:143], v[60:63], v[56:59], v[128:143]
    s_waitcnt lgkmcnt(4)
    v_mfma_f32_32x32x16_bf16 v[128:143], v[68:71], v[64:67], v[128:143]
    s_waitcnt lgkmcnt(1)
    v_mfma_f32_32x32x16_bf16 v[128:143], v[76:79], v[72:75], v[128:143]
    s_mov_b64 exec, 1
    ds_add_u32 v15, v14 offset:12
    s_mov_b64 exec, -1
    s_waitcnt lgkmcnt(1)
    v_min_u32 v80, v80, v81
    v_min_u32 v82, v82, v83
    v_readfirstlane_b32 s47, v80
    v_readfirstlane_b32 s48, v82
    s_cmp_gt_u32 s47, 3
    s_cbranch_scc1 Lqd32
Lq31:
    ds_read_b128 v[80:83], v15 offset:64
    s_waitcnt lgkmcnt(0)
    v_min_u32 v80, v80, v81
    v_min_u32 v82, v82, v83
    v_readfirstlane_b32 s47, v80
    v_readfirstlane_b32 s48, v82
    s_cmp_gt_u32 s47, 3
    s_cbranch_scc1 Lqd32
    s_sub_u32 s92, s92, 1
    s_cbranch_scc1 Lqd32
    s_branch Lq31
Lqd32:
    ds_read_b128 v[16:19], v122 offset:0
    ds_read_b64_tr_b16 v[20:21], v124 offset:0
    ds_read_b64_tr_b16 v[22:23], v124 offset:160
    ds_read_b128 v[24:27], v123 offset:0
    ds_read_b64_tr_b16 v[28:29], v124 offset:2560
    ds_read_b64_tr_b16 v[30:31], v124 offset:2720
    ds_read_b128 v[32:35], v122 offset:1024
    ds_read_b64_tr_b16 v[36:37], v124 offset:5120
    ds_read_b64_tr_b16 v[38:39], v124 offset:5280
    ds_read_b128 v[40:43], v123 offset:1024
    ds_read_b64_tr_b16 v[44:45], v124 offset:7680
    ds_read_b64_tr_b16 v[46:47], v124 offset:7840
    s_cmp_gt_u32 s48, 3
    s_cbranch_scc1 Lqd34
Lq33:
    ds_read_b128 v[80:83], v15 offset:64
    s_waitcnt lgkmcnt(0)
    v_min_u32 v80, v80, v81
    v_min_u32 v82, v82, v83
    v_readfirstlane_b32 s47, v80
    v_readfirstlane_b32 s48, v82
    s_cmp_gt_u32 s48, 3
    s_cbranch_scc1 Lqd34
    s_sub_u32 s92, s92, 1
    s_cbranch_scc1 Lqd34
    s_branch Lq33
Lqd34:
    ds_read_b128 v[48:51], v122 offset:18432
    ds_read_b64_tr_b16 v[52:53], v124 offset:18432
    ds_read_b64_tr_b16 v[54:55], v124 offset:18592
    ds_read_b128 v[56:59], v123 offset:18432
    ds_read_b64_tr_b16 v[60:61], v124 offset:20992
    ds_read_b64_tr_b16 v[62:63], v124 offset:21152
    ds_read_b128 v[64:67], v122 offset:19456
    ds_read_b64_tr_b16 v[68:69], v124 offset:23552
    ds_read_b64_tr_b16 v[70:71], v124 offset:23712
    ds_read_b128 v[72:75], v123 offset:19456
    ds_read_b64_tr_b16 v[76:77], v124 offset:26112
    ds_read_b64_tr_b16 v[78:79], v124 offset:26272
    s_waitcnt lgkmcnt(15)
    v_mfma_f32_32x32x16_bf16 v[128:143], v[20:23], v[16:19], v[128:143]
    s_waitcnt lgkmcnt(15)
    v_mfma_f32_32x32x16_bf16 v[128:143], v[28:31], v[24:27], v[128:143]
    s_waitcnt lgkmcnt(15)
    v_mfma_f32_32x32x16_bf16 v[128:143], v[36:39], v[32:35], v[128:143]
    s_waitcnt lgkmcnt(12)
    v_mfma_f32_32x32x16_bf16 v[128:143], v[44:47], v[40:43], v[128:143]
    ds_read_b128 v[80:83], v15 offset:64
    s_waitcnt lgkmcnt(10)
    v_mfma_f32_32x32x16_bf16 v[128:143], v[52:55], v[48:51], v[128:143]
    s_waitcnt lgkmcnt(7)
    v_mfma_f32_32x32x16_bf16 v[128:143], v[60:63], v[56:59], v[128:143]
    s_waitcnt lgkmcnt(4)
    v_mfma_f32_32x32x16_bf16 v[128:143], v[68:71], v[64:67], v[128:143]
    s_waitcnt lgkmcnt(1)
    v_mfma_f32_32x32x16_bf16 v[128:143], v[76:79], v[72:75], v[128:143]
    s_waitcnt lgkmcnt(0)
    v_min_u32 v80, v80, v81
    v_min_u32 v82, v82, v83
    v_readfirstlane_b32 s47, v80
    v_readfirstlane_b32 s48, v82
    s_cmp_gt_u32 s47, 4
    s_cbranch_scc1 Lqd36
Lq35:
    ds_read_b128 v[80:83], v15 offset:64
    s_waitcnt lgkmcnt(0)
    v_min_u32 v80, v80, v81
    v_min_u32 v82, v82, v83
    v_readfirstlane_b32 s47, v80
    v_readfirstlane_b32 s48, v82
    s_cmp_gt_u32 s47, 4
    s_cbranch_scc1 Lqd36
    s_sub_u32 s92, s92, 1
    s_cbranch_scc1 Lqd36
    s_branch Lq35
Lqd36:
    ds_read_b128 v[16:19], v119 offset:18432
    ds_read_b64_tr_b16 v[20:21], v121 offset:18432
    ds_read_b64_tr_b16 v[22:23], v121 offset:18592
    ds_read_b128 v[24:27], v120 offset:18432
    ds_read_b64_tr_b16 v[28:29], v121 offset:20992
    ds_read_b64_tr_b16 v[30:31], v121 offset:21152
    ds_read_b128 v[32:35], v119 offset:19456
    ds_read_b64_tr_b16 v[36:37], v121 offset:23552
    ds_read_b64_tr_b16 v[38:39], v121 offset:23712
    ds_read_b128 v[40:43], v120 offset:19456
    ds_read_b64_tr_b16 v[44:45], v121 offset:26112
    ds_read_b64_tr_b16 v[46:47], v121 offset:26272
    s_cmp_gt_u32 s48, 4
    s_cbranch_scc1 Lqd38
Lq37:
    ds_read_b128 v[80:83], v15 offset:64
    s_waitcnt lgkmcnt(0)
    v_min_u32 v80, v80, v81
    v_min_u32 v82, v82, v83
    v_readfirstlane_b32 s47, v80
    v_readfirstlane_b32 s48, v82
    s_cmp_gt_u32 s48, 4
    s_cbranch_scc1 Lqd38
    s_sub_u32 s92, s92, 1
    s_cbranch_scc1 Lqd38
    s_branch Lq37
Lqd38:
    ds_read_b128 v[48:51], v119 offset:36864
    ds_read_b64_tr_b16 v[52:53], v121 offset:36864
    ds_read_b64_tr_b16 v[54:55], v121 offset:37024
    ds_read_b128 v[56:59], v120 offset:36864
    ds_read_b64_tr_b16 v[60:61], v121 offset:39424
    ds_read_b64_tr_b16 v[62:63], v121 offset:39584
    ds_read_b128 v[64:67], v119 offset:37888
    ds_read_b64_tr_b16 v[68:69], v121 offset:41984
    ds_read_b64_tr_b16 v[70:71], v121 offset:42144
    ds_read_b128 v[72:75], v120 offset:37888
    ds_read_b64_tr_b16 v[76:77], v121 offset:44544
    ds_read_b64_tr_b16 v[78:79], v121 offset:44704
    s_waitcnt lgkmcnt(15)
    v_mfma_f32_32x32x16_bf16 v[128:143], v[20:23], v[16:19], v[128:143]
    s_waitcnt lgkmcnt(15)
    v_mfma_f32_32x32x16_bf16 v[128:143], v[28:31], v[24:27], v[128:143]
    s_waitcnt lgkmcnt(15)
    v_mfma_f32_32x32x16_bf16 v[128:143], v[36:39], v[32:35], v[128:143]
    s_waitcnt lgkmcnt(12)
    v_mfma_f32_32x32x16_bf16 v[128:143], v[44:47], v[40:43], v[128:143]
    ds_read_b32 v13, v15 offset:32
    s_waitcnt lgkmcnt(10)
    v_mfma_f32_32x32x16_bf16 v[128:143], v[52:55], v[48:51], v[128:143]
    s_waitcnt lgkmcnt(7)
    v_mfma_f32_32x32x16_bf16 v[128:143], v[60:63], v[56:59], v[128:143]
    s_waitcnt lgkmcnt(4)
    v_mfma_f32_32x32x16_bf16 v[128:143], v[68:71], v[64:67], v[128:143]
    s_waitcnt lgkmcnt(1)
    v_mfma_f32_32x32x16_bf16 v[128:143], v[76:79], v[72:75], v[128:143]
    s_mov_b32 s44, 0x3ea52b5c
    s_cmp_lt_u32 s3, 4
    s_cselect_b32 s51, 0, 22
    s_cselect_b32 s50, 0, 22
    s_waitcnt lgkmcnt(0)
    v_readfirstlane_b32 s45, v13
    s_cmp_ge_u32 s45, 1
    s_cbranch_scc1 Lq_kvok
Lw39:
    ds_read_b32 v13, v15 offset:32
    s_waitcnt lgkmcnt(0)
    v_readfirstlane_b32 s45, v13
    s_cmp_ge_u32 s45, 1
    s_cbranch_scc1 Lwd40
    s_sub_u32 s92, s92, 1
    s_cbranch_scc1 Lwd40
    s_branch Lw39
Lwd40:
Lq_kvok:
    ds_read_b128 v[72:75], v162
    ds_read_b32 v152, v163
    s_mov_b64 exec, s[94:95]
    ds_read_b128 v[144:147], v164
    ds_read_b128 v[148:151], v165
    s_mov_b64 exec, -1
    ds_read_b32 v125, v125
    v_mul_f32 v128, s44, v128
    v_mul_f32 v129, s44, v129
    v_mul_f32 v130, s44, v130
    v_mul_f32 v131, s44, v131
    v_mul_f32 v132, s44, v132
    v_mul_f32 v133, s44, v133
    v_mul_f32 v134, s44, v134
    v_mul_f32 v135, s44, v135
    v_mul_f32 v136, s44, v136
    v_mul_f32 v137, s44, v137
    v_mul_f32 v138, s44, v138
    v_mul_f32 v139, s44, v139
    v_cvt_pk_bf16_f32 v154, v136, v137
    v_cvt_pk_bf16_f32 v100, v138, v139
    v_cvt_pk_bf16_f32 v76, v128, v129
    v_cvt_pk_bf16_f32 v77, v130, v131
    v_cvt_pk_bf16_f32 v78, v132, v133
    v_cvt_pk_bf16_f32 v79, v134, v135
    v_permlane32_swap_b32 v154, v100
    s_waitcnt lgkmcnt(0)
    s_mov_b64 exec, 1
    ds_add_u32 v15, v14 offset:24
    s_mov_b64 exec, -1
    v_mfma_f32_32x32x8_bf16 v[16:31], v[152:153], v[154:155], 0
    v_mfma_f32_32x32x16_bf16 v[16:31], v[72:75], v[76:79], v[16:31]
    s_setprio 1
    s_cmp_lt_u32 s3, 4
    s_cbranch_scc1 La_noprio
    s_setprio 2
La_noprio:
    s_mov_b32 s46, 4
    s_mov_b32 s49, 0x07060302
    s_nop 7
    s_nop 3
    v_max3_f32 v100, v16, v17, v18
    v_max3_f32 v100, v100, v19, v20
    v_max3_f32 v100, v100, v21, v22
    v_max3_f32 v100, v100, v23, v24
    v_max3_f32 v100, v100, v25, v26
    v_max3_f32 v100, v100, v27, v28
    v_max3_f32 v100, v100, v29, v30
    v_max_f32 v100, v100, v31
    v_mov_b32 v101, v100
    s_nop 1
    v_permlane32_swap_b32 v101, v100
    s_nop 1
    v_max_f32 v100, v100, v101
    v_sub_f32 v100, 0, v100
    v_mov_b32 v101, 0
    v_cvt_pk_bf16_f32 v100, v100, v101
    v_cmp_gt_u32 vcc, 32, v0
    s_nop 1
    v_cndmask_b32 v155, v101, v100, vcc
    s_nop 1
    v_mfma_f32_32x32x8_bf16 v[16:31], v[152:153], v[154:155], 0
    v_mfma_f32_32x32x16_bf16 v[16:31], v[72:75], v[76:79], v[16:31]
    ds_read_b128 v[72:75], v156 offset:0
    ds_read_b32 v152, v157 offset:0
Lw41:
    ds_read_b32 v13, v15 offset:32
    s_waitcnt lgkmcnt(0)
    v_readfirstlane_b32 s44, v13
    s_cmp_ge_u32 s44, 2
    s_cbranch_scc1 Lwd42
    s_sub_u32 s92, s92, 1
    s_cbranch_scc1 Lwd42
    s_branch Lw41
Lwd42:
    s_nop 4
    v_exp_f32 v16, v16
    v_exp_f32 v17, v17
    v_exp_f32 v18, v18
    v_exp_f32 v19, v19
    v_exp_f32 v20, v20
    v_exp_f32 v21, v21
    v_pack_b32_f16 v64, v16, v17 op_sel:[1,1,0]
    v_pack_b32_f16 v65, v18, v19 op_sel:[1,1,0]
    s_waitcnt lgkmcnt(0)
    v_mfma_f32_32x32x8_bf16 v[32:47], v[152:153], v[154:155], 0
    v_exp_f32 v22, v22
    v_exp_f32 v23, v23
    v_exp_f32 v24, v24
    v_exp_f32 v25, v25
    v_pack_b32_f16 v66, v20, v21 op_sel:[1,1,0]
    v_pack_b32_f16 v67, v22, v23 op_sel:[1,1,0]
    v_mfma_f32_32x32x16_bf16 v[32:47], v[72:75], v[76:79], v[32:47]
    ds_read_b128 v[72:75], v156 offset:2576
    ds_read_b32 v152, v157 offset:2576
    v_exp_f32 v26, v26
    v_exp_f32 v27, v27
    v_exp_f32 v28, v28
    v_exp_f32 v29, v29
    v_pack_b32_f16 v68, v24, v25 op_sel:[1,1,0]
    v_pack_b32_f16 v69, v26, v27 op_sel:[1,1,0]
    v_mfma_f32_32x32x16_bf16 v[48:63], v[144:147], v[64:67], 0
    v_exp_f32 v30, v30
    v_exp_f32 v31, v31
    v_pack_b32_f16 v70, v28, v29 op_sel:[1,1,0]
    v_pack_b32_f16 v71, v30, v31 op_sel:[1,1,0]
Lw43:
    ds_read_b32 v13, v15 offset:32
    s_waitcnt lgkmcnt(0)
    v_readfirstlane_b32 s44, v13
    s_cmp_ge_u32 s44, 4
    s_cbranch_scc1 Lwd44
    s_sub_u32 s92, s92, 1
    s_cbranch_scc1 Lwd44
    s_branch Lw43
Lwd44:
    v_add_u32 v160, 96, v15
Lattn_loop:
    v_exp_f32 v32, v32
    v_exp_f32 v33, v33
    v_mfma_f32_32x32x16_bf16 v[48:63], v[148:151], v[68:71], v[48:63]
    ds_read_b128 v[144:147], v158 offset:0
    ds_read_b128 v[148:151], v159 offset:0
    v_exp_f32 v34, v34
    v_exp_f32 v35, v35
    v_exp_f32 v36, v36
    v_exp_f32 v37, v37
    v_pack_b32_f16 v64, v32, v33 op_sel:[1,1,0]
    v_pack_b32_f16 v65, v34, v35 op_sel:[1,1,0]
    s_waitcnt lgkmcnt(2)
    v_mfma_f32_32x32x8_bf16 v[16:31], v[152:153], v[154:155], 0
    v_exp_f32 v38, v38
    v_exp_f32 v39, v39
    v_exp_f32 v40, v40
    v_exp_f32 v41, v41
    v_pack_b32_f16 v66, v36, v37 op_sel:[1,1,0]
    v_pack_b32_f16 v67, v38, v39 op_sel:[1,1,0]
    v_mfma_f32_32x32x16_bf16 v[16:31], v[72:75], v[76:79], v[16:31]
    ds_read_b128 v[72:75], v156 offset:5152
    ds_read_b32 v152, v157 offset:5152
    v_exp_f32 v42, v42
    v_exp_f32 v43, v43
    v_exp_f32 v44, v44
    v_exp_f32 v45, v45
    v_pack_b32_f16 v68, v40, v41 op_sel:[1,1,0]
    v_pack_b32_f16 v69, v42, v43 op_sel:[1,1,0]
    s_waitcnt lgkmcnt(2)
    v_mfma_f32_32x32x16_bf16 v[48:63], v[144:147], v[64:67], v[48:63]
    v_exp_f32 v46, v46
    v_exp_f32 v47, v47
    v_pack_b32_f16 v70, v44, v45 op_sel:[1,1,0]
    v_pack_b32_f16 v71, v46, v47 op_sel:[1,1,0]
    v_exp_f32 v16, v16
    v_exp_f32 v17, v17
    v_mfma_f32_32x32x16_bf16 v[48:63], v[148:151], v[68:71], v[48:63]
    ds_read_b128 v[144:147], v158 offset:2576
    ds_read_b128 v[148:151], v159 offset:2576
    v_exp_f32 v18, v18
    v_exp_f32 v19, v19
    v_exp_f32 v20, v20
    v_exp_f32 v21, v21
    v_pack_b32_f16 v64, v16, v17 op_sel:[1,1,0]
    v_pack_b32_f16 v65, v18, v19 op_sel:[1,1,0]
    s_waitcnt lgkmcnt(2)
    v_mfma_f32_32x32x8_bf16 v[32:47], v[152:153], v[154:155], 0
    v_exp_f32 v22, v22
    v_exp_f32 v23, v23
    v_exp_f32 v24, v24
    v_exp_f32 v25, v25
    v_pack_b32_f16 v66, v20, v21 op_sel:[1,1,0]
    v_pack_b32_f16 v67, v22, v23 op_sel:[1,1,0]
    v_mfma_f32_32x32x16_bf16 v[32:47], v[72:75], v[76:79], v[32:47]
    ds_read_b128 v[72:75], v156 offset:7728
    ds_read_b32 v152, v157 offset:7728
    v_exp_f32 v26, v26
    v_exp_f32 v27, v27
    v_exp_f32 v28, v28
    v_exp_f32 v29, v29
    v_pack_b32_f16 v68, v24, v25 op_sel:[1,1,0]
    v_pack_b32_f16 v69, v26, v27 op_sel:[1,1,0]
    s_waitcnt lgkmcnt(2)
    v_mfma_f32_32x32x16_bf16 v[48:63], v[144:147], v[64:67], v[48:63]
    v_exp_f32 v30, v30
    v_exp_f32 v31, v31
    v_pack_b32_f16 v70, v28, v29 op_sel:[1,1,0]
    v_pack_b32_f16 v71, v30, v31 op_sel:[1,1,0]
    v_exp_f32 v32, v32
    v_exp_f32 v33, v33
    v_mfma_f32_32x32x16_bf16 v[48:63], v[148:151], v[68:71], v[48:63]
    ds_read_b128 v[144:147], v158 offset:5152
    ds_read_b128 v[148:151], v159 offset:5152
    v_exp_f32 v34, v34
    v_exp_f32 v35, v35
    v_exp_f32 v36, v36
    v_exp_f32 v37, v37
    v_pack_b32_f16 v64, v32, v33 op_sel:[1,1,0]
    v_pack_b32_f16 v65, v34, v35 op_sel:[1,1,0]
    s_waitcnt lgkmcnt(2)
    v_mfma_f32_32x32x8_bf16 v[16:31], v[152:153], v[154:155], 0
    v_exp_f32 v38, v38
    v_exp_f32 v39, v39
    v_exp_f32 v40, v40
    v_exp_f32 v41, v41
    v_pack_b32_f16 v66, v36, v37 op_sel:[1,1,0]
    v_pack_b32_f16 v67, v38, v39 op_sel:[1,1,0]
    v_mfma_f32_32x32x16_bf16 v[16:31], v[72:75], v[76:79], v[16:31]
    ds_read_b128 v[72:75], v156 offset:10304
    ds_read_b32 v152, v157 offset:10304
    v_exp_f32 v42, v42
    v_exp_f32 v43, v43
    v_exp_f32 v44, v44
    v_exp_f32 v45, v45
    v_pack_b32_f16 v68, v40, v41 op_sel:[1,1,0]
    v_pack_b32_f16 v69, v42, v43 op_sel:[1,1,0]
    s_waitcnt lgkmcnt(2)
    v_mfma_f32_32x32x16_bf16 v[48:63], v[144:147], v[64:67], v[48:63]
    v_exp_f32 v46, v46
    v_exp_f32 v47, v47
    v_pack_b32_f16 v70, v44, v45 op_sel:[1,1,0]
    v_pack_b32_f16 v71, v46, v47 op_sel:[1,1,0]
    v_exp_f32 v16, v16
    v_exp_f32 v17, v17
    v_mfma_f32_32x32x16_bf16 v[48:63], v[148:151], v[68:71], v[48:63]
    ds_read_b32 v161, v15 offset:32
    ds_read_b128 v[144:147], v158 offset:7728
    ds_read_b128 v[148:151], v159 offset:7728
    v_exp_f32 v18, v18
    v_exp_f32 v19, v19
    v_exp_f32 v20, v20
    v_exp_f32 v21, v21
    v_pack_b32_f16 v64, v16, v17 op_sel:[1,1,0]
    v_pack_b32_f16 v65, v18, v19 op_sel:[1,1,0]
    s_waitcnt lgkmcnt(2)
    v_mfma_f32_32x32x8_bf16 v[32:47], v[152:153], v[154:155], 0
    v_exp_f32 v22, v22
    v_exp_f32 v23, v23
    v_exp_f32 v24, v24
    v_exp_f32 v25, v25
    v_pack_b32_f16 v66, v20, v21 op_sel:[1,1,0]
    v_pack_b32_f16 v67, v22, v23 op_sel:[1,1,0]
    v_mfma_f32_32x32x16_bf16 v[32:47], v[72:75], v[76:79], v[32:47]
    ds_read_b128 v[72:75], v156 offset:12880
    ds_read_b32 v152, v157 offset:12880
    v_exp_f32 v26, v26
    v_exp_f32 v27, v27
    v_exp_f32 v28, v28
    v_exp_f32 v29, v29
    v_pack_b32_f16 v68, v24, v25 op_sel:[1,1,0]
    v_pack_b32_f16 v69, v26, v27 op_sel:[1,1,0]
    s_waitcnt lgkmcnt(2)
    v_mfma_f32_32x32x16_bf16 v[48:63], v[144:147], v[64:67], v[48:63]
    v_exp_f32 v30, v30
    v_exp_f32 v31, v31
    v_pack_b32_f16 v70, v28, v29 op_sel:[1,1,0]
    v_pack_b32_f16 v71, v30, v31 op_sel:[1,1,0]
    s_cmp_lg_u32 s46, s51
    s_cbranch_scc1 Lattn_p1
    s_setprio 1
Lattn_p1:
    v_readfirstlane_b32 s47, v161
    s_add_u32 s46, s46, 2
    s_cmp_lt_u32 s47, s46
    s_cbranch_scc1 Lattn_slow3
Lattn_cont3:
    v_exp_f32 v32, v32
    v_exp_f32 v33, v33
    v_mfma_f32_32x32x16_bf16 v[48:63], v[148:151], v[68:71], v[48:63]
    ds_read_b128 v[144:147], v158 offset:10304
    ds_read_b128 v[148:151], v159 offset:10304
    v_exp_f32 v34, v34
    v_exp_f32 v35, v35
    v_exp_f32 v36, v36
    v_exp_f32 v37, v37
    v_pack_b32_f16 v64, v32, v33 op_sel:[1,1,0]
    v_pack_b32_f16 v65, v34, v35 op_sel:[1,1,0]
    s_waitcnt lgkmcnt(2)
    v_mfma_f32_32x32x8_bf16 v[16:31], v[152:153], v[154:155], 0
    v_exp_f32 v38, v38
    v_exp_f32 v39, v39
    v_exp_f32 v40, v40
    v_exp_f32 v41, v41
    v_pack_b32_f16 v66, v36, v37 op_sel:[1,1,0]
    v_pack_b32_f16 v67, v38, v39 op_sel:[1,1,0]
    v_mfma_f32_32x32x16_bf16 v[16:31], v[72:75], v[76:79], v[16:31]
    ds_read_b128 v[72:75], v156 offset:15456
    ds_read_b32 v152, v157 offset:15456
    v_exp_f32 v42, v42
    v_exp_f32 v43, v43
    v_exp_f32 v44, v44
    v_exp_f32 v45, v45
    v_pack_b32_f16 v68, v40, v41 op_sel:[1,1,0]
    v_pack_b32_f16 v69, v42, v43 op_sel:[1,1,0]
    s_waitcnt lgkmcnt(2)
    v_mfma_f32_32x32x16_bf16 v[48:63], v[144:147], v[64:67], v[48:63]
    v_exp_f32 v46, v46
    v_exp_f32 v47, v47
    v_pack_b32_f16 v70, v44, v45 op_sel:[1,1,0]
    v_pack_b32_f16 v71, v46, v47 op_sel:[1,1,0]
    v_exp_f32 v16, v16
    v_exp_f32 v17, v17
    v_mfma_f32_32x32x16_bf16 v[48:63], v[148:151], v[68:71], v[48:63]
    ds_read_b128 v[144:147], v158 offset:12880
    ds_read_b128 v[148:151], v159 offset:12880
    v_exp_f32 v18, v18
    v_exp_f32 v19, v19
    v_exp_f32 v20, v20
    v_exp_f32 v21, v21
    v_pack_b32_f16 v64, v16, v17 op_sel:[1,1,0]
    v_pack_b32_f16 v65, v18, v19 op_sel:[1,1,0]
    s_waitcnt lgkmcnt(2)
    v_mfma_f32_32x32x8_bf16 v[32:47], v[152:153], v[154:155], 0
    v_exp_f32 v22, v22
    v_exp_f32 v23, v23
    v_exp_f32 v24, v24
    v_exp_f32 v25, v25
    v_pack_b32_f16 v66, v20, v21 op_sel:[1,1,0]
    v_pack_b32_f16 v67, v22, v23 op_sel:[1,1,0]
    v_mfma_f32_32x32x16_bf16 v[32:47], v[72:75], v[76:79], v[32:47]
    ds_read_b128 v[72:75], v156 offset:18032
    ds_read_b32 v152, v157 offset:18032
    v_exp_f32 v26, v26
    v_exp_f32 v27, v27
    v_exp_f32 v28, v28
    v_exp_f32 v29, v29
    v_pack_b32_f16 v68, v24, v25 op_sel:[1,1,0]
    v_pack_b32_f16 v69, v26, v27 op_sel:[1,1,0]
    s_waitcnt lgkmcnt(2)
    v_mfma_f32_32x32x16_bf16 v[48:63], v[144:147], v[64:67], v[48:63]
    v_exp_f32 v30, v30
    v_exp_f32 v31, v31
    v_pack_b32_f16 v70, v28, v29 op_sel:[1,1,0]
    v_pack_b32_f16 v71, v30, v31 op_sel:[1,1,0]
    v_exp_f32 v32, v32
    v_exp_f32 v33, v33
    v_mfma_f32_32x32x16_bf16 v[48:63], v[148:151], v[68:71], v[48:63]
    ds_read_b128 v[144:147], v158 offset:15456
    ds_read_b128 v[148:151], v159 offset:15456
    v_exp_f32 v34, v34
    v_exp_f32 v35, v35
    v_exp_f32 v36, v36
    v_exp_f32 v37, v37
    v_pack_b32_f16 v64, v32, v33 op_sel:[1,1,0]
    v_pack_b32_f16 v65, v34, v35 op_sel:[1,1,0]
    s_waitcnt lgkmcnt(2)
    v_mfma_f32_32x32x8_bf16 v[16:31], v[152:153], v[154:155], 0
    v_exp_f32 v38, v38
    v_exp_f32 v39, v39
    v_exp_f32 v40, v40
    v_exp_f32 v41, v41
    v_pack_b32_f16 v66, v36, v37 op_sel:[1,1,0]
    v_pack_b32_f16 v67, v38, v39 op_sel:[1,1,0]
    v_mfma_f32_32x32x16_bf16 v[16:31], v[72:75], v[76:79], v[16:31]
    ds_read_b128 v[72:75], v156 offset:20608
    ds_read_b32 v152, v157 offset:20608
    v_exp_f32 v42, v42
    v_exp_f32 v43, v43
    v_exp_f32 v44, v44
    v_exp_f32 v45, v45
    v_pack_b32_f16 v68, v40, v41 op_sel:[1,1,0]
    v_pack_b32_f16 v69, v42, v43 op_sel:[1,1,0]
    s_waitcnt lgkmcnt(2)
    v_mfma_f32_32x32x16_bf16 v[48:63], v[144:147], v[64:67], v[48:63]
    v_exp_f32 v46, v46
    v_exp_f32 v47, v47
    v_pack_b32_f16 v70, v44, v45 op_sel:[1,1,0]
    v_pack_b32_f16 v71, v46, v47 op_sel:[1,1,0]
    v_exp_f32 v16, v16
    v_exp_f32 v17, v17
    v_mfma_f32_32x32x16_bf16 v[48:63], v[148:151], v[68:71], v[48:63]
    ds_read_b32 v161, v15 offset:32
    ds_read_b128 v[144:147], v158 offset:18032
    ds_read_b128 v[148:151], v159 offset:18032
    v_exp_f32 v18, v18
    v_exp_f32 v19, v19
    v_exp_f32 v20, v20
    v_exp_f32 v21, v21
    v_pack_b32_f16 v64, v16, v17 op_sel:[1,1,0]
    v_pack_b32_f16 v65, v18, v19 op_sel:[1,1,0]
    s_waitcnt lgkmcnt(2)
    v_mfma_f32_32x32x8_bf16 v[32:47], v[152:153], v[154:155], 0
    v_exp_f32 v22, v22
    v_exp_f32 v23, v23
    v_exp_f32 v24, v24
    v_exp_f32 v25, v25
    v_pack_b32_f16 v66, v20, v21 op_sel:[1,1,0]
    v_pack_b32_f16 v67, v22, v23 op_sel:[1,1,0]
    v_mfma_f32_32x32x16_bf16 v[32:47], v[72:75], v[76:79], v[32:47]
    ds_read_b128 v[72:75], v156 offset:23184
    ds_read_b32 v152, v157 offset:23184
    v_exp_f32 v26, v26
    v_exp_f32 v27, v27
    v_exp_f32 v28, v28
    v_exp_f32 v29, v29
    v_pack_b32_f16 v68, v24, v25 op_sel:[1,1,0]
    v_pack_b32_f16 v69, v26, v27 op_sel:[1,1,0]
    s_waitcnt lgkmcnt(2)
    v_mfma_f32_32x32x16_bf16 v[48:63], v[144:147], v[64:67], v[48:63]
    v_exp_f32 v30, v30
    v_exp_f32 v31, v31
    v_pack_b32_f16 v70, v28, v29 op_sel:[1,1,0]
    v_pack_b32_f16 v71, v30, v31 op_sel:[1,1,0]
    v_readfirstlane_b32 s47, v161
    s_add_u32 s46, s46, 2
    s_cmp_lt_u32 s47, s46
    s_cbranch_scc1 Lattn_slow7
Lattn_cont7:
    v_exp_f32 v32, v32
    v_exp_f32 v33, v33
    v_mfma_f32_32x32x16_bf16 v[48:63], v[148:151], v[68:71], v[48:63]
    ds_read_b128 v[144:147], v158 offset:20608
    ds_read_b128 v[148:151], v159 offset:20608
    v_exp_f32 v34, v34
    v_exp_f32 v35, v35
    v_exp_f32 v36, v36
    v_exp_f32 v37, v37
    v_pack_b32_f16 v64, v32, v33 op_sel:[1,1,0]
    v_pack_b32_f16 v65, v34, v35 op_sel:[1,1,0]
    s_waitcnt lgkmcnt(2)
    v_mfma_f32_32x32x8_bf16 v[16:31], v[152:153], v[154:155], 0
    v_exp_f32 v38, v38
    v_exp_f32 v39, v39
    v_exp_f32 v40, v40
    v_exp_f32 v41, v41
    v_pack_b32_f16 v66, v36, v37 op_sel:[1,1,0]
    v_pack_b32_f16 v67, v38, v39 op_sel:[1,1,0]
    v_mfma_f32_32x32x16_bf16 v[16:31], v[72:75], v[76:79], v[16:31]
    ds_read_b128 v[72:75], v156 offset:25760
    ds_read_b32 v152, v157 offset:25760
    v_exp_f32 v42, v42
    v_exp_f32 v43, v43
    v_exp_f32 v44, v44
    v_exp_f32 v45, v45
    v_pack_b32_f16 v68, v40, v41 op_sel:[1,1,0]
    v_pack_b32_f16 v69, v42, v43 op_sel:[1,1,0]
    s_waitcnt lgkmcnt(2)
    v_mfma_f32_32x32x16_bf16 v[48:63], v[144:147], v[64:67], v[48:63]
    v_exp_f32 v46, v46
    v_exp_f32 v47, v47
    v_pack_b32_f16 v70, v44, v45 op_sel:[1,1,0]
    v_pack_b32_f16 v71, v46, v47 op_sel:[1,1,0]
    v_exp_f32 v16, v16
    v_exp_f32 v17, v17
    v_mfma_f32_32x32x16_bf16 v[48:63], v[148:151], v[68:71], v[48:63]
    ds_read_b128 v[144:147], v158 offset:23184
    ds_read_b128 v[148:151], v159 offset:23184
    v_exp_f32 v18, v18
    v_exp_f32 v19, v19
    v_exp_f32 v20, v20
    v_exp_f32 v21, v21
    v_pack_b32_f16 v64, v16, v17 op_sel:[1,1,0]
    v_pack_b32_f16 v65, v18, v19 op_sel:[1,1,0]
    s_waitcnt lgkmcnt(2)
    v_mfma_f32_32x32x8_bf16 v[32:47], v[152:153], v[154:155], 0
    v_exp_f32 v22, v22
    v_exp_f32 v23, v23
    v_exp_f32 v24, v24
    v_exp_f32 v25, v25
    v_pack_b32_f16 v66, v20, v21 op_sel:[1,1,0]
    v_pack_b32_f16 v67, v22, v23 op_sel:[1,1,0]
    v_mfma_f32_32x32x16_bf16 v[32:47], v[72:75], v[76:79], v[32:47]
    ds_read_b128 v[72:75], v156 offset:28336
    ds_read_b32 v152, v157 offset:28336
    v_exp_f32 v26, v26
    v_exp_f32 v27, v27
    v_exp_f32 v28, v28
    v_exp_f32 v29, v29
    v_pack_b32_f16 v68, v24, v25 op_sel:[1,1,0]
    v_pack_b32_f16 v69, v26, v27 op_sel:[1,1,0]
    s_waitcnt lgkmcnt(2)
    v_mfma_f32_32x32x16_bf16 v[48:63], v[144:147], v[64:67], v[48:63]
    v_exp_f32 v30, v30
    v_exp_f32 v31, v31
    v_pack_b32_f16 v70, v28, v29 op_sel:[1,1,0]
    v_pack_b32_f16 v71, v30, v31 op_sel:[1,1,0]
    v_exp_f32 v32, v32
    v_exp_f32 v33, v33
    v_mfma_f32_32x32x16_bf16 v[48:63], v[148:151], v[68:71], v[48:63]
    ds_read_b128 v[144:147], v158 offset:25760
    ds_read_b128 v[148:151], v159 offset:25760
    v_exp_f32 v34, v34
    v_exp_f32 v35, v35
    v_exp_f32 v36, v36
    v_exp_f32 v37, v37
    v_pack_b32_f16 v64, v32, v33 op_sel:[1,1,0]
    v_pack_b32_f16 v65, v34, v35 op_sel:[1,1,0]
    s_waitcnt lgkmcnt(2)
    v_mfma_f32_32x32x8_bf16 v[16:31], v[152:153], v[154:155], 0
    v_exp_f32 v38, v38
    v_exp_f32 v39, v39
    v_exp_f32 v40, v40
    v_exp_f32 v41, v41
    v_pack_b32_f16 v66, v36, v37 op_sel:[1,1,0]
    v_pack_b32_f16 v67, v38, v39 op_sel:[1,1,0]
    v_mfma_f32_32x32x16_bf16 v[16:31], v[72:75], v[76:79], v[16:31]
    ds_read_b128 v[72:75], v156 offset:30912
    ds_read_b32 v152, v157 offset:30912
    v_exp_f32 v42, v42
    v_exp_f32 v43, v43
    v_exp_f32 v44, v44
    v_exp_f32 v45, v45
    v_pack_b32_f16 v68, v40, v41 op_sel:[1,1,0]
    v_pack_b32_f16 v69, v42, v43 op_sel:[1,1,0]
    s_waitcnt lgkmcnt(2)
    v_mfma_f32_32x32x16_bf16 v[48:63], v[144:147], v[64:67], v[48:63]
    v_exp_f32 v46, v46
    v_exp_f32 v47, v47
    v_pack_b32_f16 v70, v44, v45 op_sel:[1,1,0]
    v_pack_b32_f16 v71, v46, v47 op_sel:[1,1,0]
    v_exp_f32 v16, v16
    v_exp_f32 v17, v17
    v_mfma_f32_32x32x16_bf16 v[48:63], v[148:151], v[68:71], v[48:63]
    ds_read_b32 v161, v15 offset:32
    ds_read_b128 v[144:147], v158 offset:28336
    ds_read_b128 v[148:151], v159 offset:28336
    v_exp_f32 v18, v18
    v_exp_f32 v19, v19
    v_exp_f32 v20, v20
    v_exp_f32 v21, v21
    v_pack_b32_f16 v64, v16, v17 op_sel:[1,1,0]
    v_pack_b32_f16 v65, v18, v19 op_sel:[1,1,0]
    s_waitcnt lgkmcnt(2)
    v_mfma_f32_32x32x8_bf16 v[32:47], v[152:153], v[154:155], 0
    v_exp_f32 v22, v22
    v_exp_f32 v23, v23
    v_exp_f32 v24, v24
    v_exp_f32 v25, v25
    v_pack_b32_f16 v66, v20, v21 op_sel:[1,1,0]
    v_pack_b32_f16 v67, v22, v23 op_sel:[1,1,0]
    v_mfma_f32_32x32x16_bf16 v[32:47], v[72:75], v[76:79], v[32:47]
    ds_read_b128 v[72:75], v156 offset:33488
    ds_read_b32 v152, v157 offset:33488
    v_exp_f32 v26, v26
    v_exp_f32 v27, v27
    v_exp_f32 v28, v28
    v_exp_f32 v29, v29
    v_pack_b32_f16 v68, v24, v25 op_sel:[1,1,0]
    v_pack_b32_f16 v69, v26, v27 op_sel:[1,1,0]
    s_waitcnt lgkmcnt(2)
    v_mfma_f32_32x32x16_bf16 v[48:63], v[144:147], v[64:67], v[48:63]
    v_exp_f32 v30, v30
    v_exp_f32 v31, v31
    v_pack_b32_f16 v70, v28, v29 op_sel:[1,1,0]
    v_pack_b32_f16 v71, v30, v31 op_sel:[1,1,0]
    v_add_u32 v156, 30912, v156
    v_add_u32 v157, 30912, v157
    v_readfirstlane_b32 s47, v161
    v_add_u32 v158, 30912, v158
    v_add_u32 v159, 30912, v159
    s_add_u32 s46, s46, 2
    s_cmp_gt_u32 s46, 32
    s_cbranch_scc1 Lattn_tail
    s_mov_b64 exec, 1
    ds_add_u32 v160, v14 offset:0
    s_mov_b64 exec, -1
    v_add_u32 v160, 4, v160
    s_cmp_lt_u32 s47, s46
    s_cbranch_scc1 Lattn_slow11
Lattn_cont11:
    s_cmp_lt_u32 s47, 32
    s_cbranch_scc1 Lattn_loop
Lattn_loopb:
    v_exp_f32 v32, v32
    v_exp_f32 v33, v33
    v_mfma_f32_32x32x16_bf16 v[48:63], v[148:151], v[68:71], v[48:63]
    ds_read_b128 v[144:147], v158 offset:0
    ds_read_b128 v[148:151], v159 offset:0
    v_exp_f32 v34, v34
    v_exp_f32 v35, v35
    v_exp_f32 v36, v36
    v_exp_f32 v37, v37
    v_pack_b32_f16 v64, v32, v33 op_sel:[1,1,0]
    v_pack_b32_f16 v65, v34, v35 op_sel:[1,1,0]
    s_waitcnt lgkmcnt(2)
    v_mfma_f32_32x32x8_bf16 v[16:31], v[152:153], v[154:155], 0
    v_exp_f32 v38, v38
    v_exp_f32 v39, v39
    v_exp_f32 v40, v40
    v_exp_f32 v41, v41
    v_pack_b32_f16 v66, v36, v37 op_sel:[1,1,0]
    v_pack_b32_f16 v67, v38, v39 op_sel:[1,1,0]
    v_mfma_f32_32x32x16_bf16 v[16:31], v[72:75], v[76:79], v[16:31]
    ds_read_b128 v[72:75], v156 offset:5152
    ds_read_b32 v152, v157 offset:5152
    v_exp_f32 v42, v42
    v_exp_f32 v43, v43
    v_exp_f32 v44, v44
    v_exp_f32 v45, v45
    v_pack_b32_f16 v68, v40, v41 op_sel:[1,1,0]
    v_pack_b32_f16 v69, v42, v43 op_sel:[1,1,0]
    s_waitcnt lgkmcnt(2)
    v_mfma_f32_32x32x16_bf16 v[48:63], v[144:147], v[64:67], v[48:63]
    v_exp_f32 v46, v46
    v_exp_f32 v47, v47
    v_pack_b32_f16 v70, v44, v45 op_sel:[1,1,0]
    v_pack_b32_f16 v71, v46, v47 op_sel:[1,1,0]
    v_exp_f32 v16, v16
    v_exp_f32 v17, v17
    v_mfma_f32_32x32x16_bf16 v[48:63], v[148:151], v[68:71], v[48:63]
    ds_read_b128 v[144:147], v158 offset:2576
    ds_read_b128 v[148:151], v159 offset:2576
    v_exp_f32 v18, v18
    v_exp_f32 v19, v19
    v_exp_f32 v20, v20
    v_exp_f32 v21, v21
    v_pack_b32_f16 v64, v16, v17 op_sel:[1,1,0]
    v_pack_b32_f16 v65, v18, v19 op_sel:[1,1,0]
    s_waitcnt lgkmcnt(2)
    v_mfma_f32_32x32x8_bf16 v[32:47], v[152:153], v[154:155], 0
    v_exp_f32 v22, v22
    v_exp_f32 v23, v23
    v_exp_f32 v24, v24
    v_exp_f32 v25, v25
    v_pack_b32_f16 v66, v20, v21 op_sel:[1,1,0]
    v_pack_b32_f16 v67, v22, v23 op_sel:[1,1,0]
    v_mfma_f32_32x32x16_bf16 v[32:47], v[72:75], v[76:79], v[32:47]
    ds_read_b128 v[72:75], v156 offset:7728
    ds_read_b32 v152, v157 offset:7728
    v_exp_f32 v26, v26
    v_exp_f32 v27, v27
    v_exp_f32 v28, v28
    v_exp_f32 v29, v29
    v_pack_b32_f16 v68, v24, v25 op_sel:[1,1,0]
    v_pack_b32_f16 v69, v26, v27 op_sel:[1,1,0]
    s_waitcnt lgkmcnt(2)
    v_mfma_f32_32x32x16_bf16 v[48:63], v[144:147], v[64:67], v[48:63]
    v_exp_f32 v30, v30
    v_exp_f32 v31, v31
    v_pack_b32_f16 v70, v28, v29 op_sel:[1,1,0]
    v_pack_b32_f16 v71, v30, v31 op_sel:[1,1,0]
    v_exp_f32 v32, v32
    v_exp_f32 v33, v33
    v_mfma_f32_32x32x16_bf16 v[48:63], v[148:151], v[68:71], v[48:63]
    ds_read_b128 v[144:147], v158 offset:5152
    ds_read_b128 v[148:151], v159 offset:5152
    v_exp_f32 v34, v34
    v_exp_f32 v35, v35
    v_exp_f32 v36, v36
    v_exp_f32 v37, v37
    v_pack_b32_f16 v64, v32, v33 op_sel:[1,1,0]
    v_pack_b32_f16 v65, v34, v35 op_sel:[1,1,0]
    s_waitcnt lgkmcnt(2)
    v_mfma_f32_32x32x8_bf16 v[16:31], v[152:153], v[154:155], 0
    v_exp_f32 v38, v38
    v_exp_f32 v39, v39
    v_exp_f32 v40, v40
    v_exp_f32 v41, v41
    v_pack_b32_f16 v66, v36, v37 op_sel:[1,1,0]
    v_pack_b32_f16 v67, v38, v39 op_sel:[1,1,0]
    v_mfma_f32_32x32x16_bf16 v[16:31], v[72:75], v[76:79], v[16:31]
    ds_read_b128 v[72:75], v156 offset:10304
    ds_read_b32 v152, v157 offset:10304
    v_exp_f32 v42, v42
    v_exp_f32 v43, v43
    v_exp_f32 v44, v44
    v_exp_f32 v45, v45
    v_pack_b32_f16 v68, v40, v41 op_sel:[1,1,0]
    v_pack_b32_f16 v69, v42, v43 op_sel:[1,1,0]
    s_waitcnt lgkmcnt(2)
    v_mfma_f32_32x32x16_bf16 v[48:63], v[144:147], v[64:67], v[48:63]
    v_exp_f32 v46, v46
    v_exp_f32 v47, v47
    v_pack_b32_f16 v70, v44, v45 op_sel:[1,1,0]
    v_pack_b32_f16 v71, v46, v47 op_sel:[1,1,0]
    v_exp_f32 v16, v16
    v_exp_f32 v17, v17
    v_mfma_f32_32x32x16_bf16 v[48:63], v[148:151], v[68:71], v[48:63]
    ds_read_b128 v[144:147], v158 offset:7728
    ds_read_b128 v[148:151], v159 offset:7728
    v_exp_f32 v18, v18
    v_exp_f32 v19, v19
    v_exp_f32 v20, v20
    v_exp_f32 v21, v21
    v_pack_b32_f16 v64, v16, v17 op_sel:[1,1,0]
    v_pack_b32_f16 v65, v18, v19 op_sel:[1,1,0]
    s_waitcnt lgkmcnt(2)
    v_mfma_f32_32x32x8_bf16 v[32:47], v[152:153], v[154:155], 0
    v_exp_f32 v22, v22
    v_exp_f32 v23, v23
    v_exp_f32 v24, v24
    v_exp_f32 v25, v25
    v_pack_b32_f16 v66, v20, v21 op_sel:[1,1,0]
    v_pack_b32_f16 v67, v22, v23 op_sel:[1,1,0]
    v_mfma_f32_32x32x16_bf16 v[32:47], v[72:75], v[76:79], v[32:47]
    ds_read_b128 v[72:75], v156 offset:12880
    ds_read_b32 v152, v157 offset:12880
    v_exp_f32 v26, v26
    v_exp_f32 v27, v27
    v_exp_f32 v28, v28
    v_exp_f32 v29, v29
    v_pack_b32_f16 v68, v24, v25 op_sel:[1,1,0]
    v_pack_b32_f16 v69, v26, v27 op_sel:[1,1,0]
    s_waitcnt lgkmcnt(2)
    v_mfma_f32_32x32x16_bf16 v[48:63], v[144:147], v[64:67], v[48:63]
    v_exp_f32 v30, v30
    v_exp_f32 v31, v31
    v_pack_b32_f16 v70, v28, v29 op_sel:[1,1,0]
    v_pack_b32_f16 v71, v30, v31 op_sel:[1,1,0]
    s_cmp_lg_u32 s46, s50
    s_cbranch_scc1 Lattn_p0
    s_setprio 1
Lattn_p0:
    v_exp_f32 v32, v32
    v_exp_f32 v33, v33
    v_mfma_f32_32x32x16_bf16 v[48:63], v[148:151], v[68:71], v[48:63]
    ds_read_b128 v[144:147], v158 offset:10304
    ds_read_b128 v[148:151], v159 offset:10304
    v_exp_f32 v34, v34
    v_exp_f32 v35, v35
    v_exp_f32 v36, v36
    v_exp_f32 v37, v37
    v_pack_b32_f16 v64, v32, v33 op_sel:[1,1,0]
    v_pack_b32_f16 v65, v34, v35 op_sel:[1,1,0]
    s_waitcnt lgkmcnt(2)
    v_mfma_f32_32x32x8_bf16 v[16:31], v[152:153], v[154:155], 0
    v_exp_f32 v38, v38
    v_exp_f32 v39, v39
    v_exp_f32 v40, v40
    v_exp_f32 v41, v41
    v_pack_b32_f16 v66, v36, v37 op_sel:[1,1,0]
    v_pack_b32_f16 v67, v38, v39 op_sel:[1,1,0]
    v_mfma_f32_32x32x16_bf16 v[16:31], v[72:75], v[76:79], v[16:31]
    ds_read_b128 v[72:75], v156 offset:15456
    ds_read_b32 v152, v157 offset:15456
    v_exp_f32 v42, v42
    v_exp_f32 v43, v43
    v_exp_f32 v44, v44
    v_exp_f32 v45, v45
    v_pack_b32_f16 v68, v40, v41 op_sel:[1,1,0]
    v_pack_b32_f16 v69, v42, v43 op_sel:[1,1,0]
    s_waitcnt lgkmcnt(2)
    v_mfma_f32_32x32x16_bf16 v[48:63], v[144:147], v[64:67], v[48:63]
    v_exp_f32 v46, v46
    v_exp_f32 v47, v47
    v_pack_b32_f16 v70, v44, v45 op_sel:[1,1,0]
    v_pack_b32_f16 v71, v46, v47 op_sel:[1,1,0]
    v_exp_f32 v16, v16
    v_exp_f32 v17, v17
    v_mfma_f32_32x32x16_bf16 v[48:63], v[148:151], v[68:71], v[48:63]
    ds_read_b128 v[144:147], v158 offset:12880
    ds_read_b128 v[148:151], v159 offset:12880
    v_exp_f32 v18, v18
    v_exp_f32 v19, v19
    v_exp_f32 v20, v20
    v_exp_f32 v21, v21
    v_pack_b32_f16 v64, v16, v17 op_sel:[1,1,0]
    v_pack_b32_f16 v65, v18, v19 op_sel:[1,1,0]
    s_waitcnt lgkmcnt(2)
    v_mfma_f32_32x32x8_bf16 v[32:47], v[152:153], v[154:155], 0
    v_exp_f32 v22, v22
    v_exp_f32 v23, v23
    v_exp_f32 v24, v24
    v_exp_f32 v25, v25
    v_pack_b32_f16 v66, v20, v21 op_sel:[1,1,0]
    v_pack_b32_f16 v67, v22, v23 op_sel:[1,1,0]
    v_mfma_f32_32x32x16_bf16 v[32:47], v[72:75], v[76:79], v[32:47]
    ds_read_b128 v[72:75], v156 offset:18032
    ds_read_b32 v152, v157 offset:18032
    v_exp_f32 v26, v26
    v_exp_f32 v27, v27
    v_exp_f32 v28, v28
    v_exp_f32 v29, v29
    v_pack_b32_f16 v68, v24, v25 op_sel:[1,1,0]
    v_pack_b32_f16 v69, v26, v27 op_sel:[1,1,0]
    s_waitcnt lgkmcnt(2)
    v_mfma_f32_32x32x16_bf16 v[48:63], v[144:147], v[64:67], v[48:63]
    v_exp_f32 v30, v30
    v_exp_f32 v31, v31
    v_pack_b32_f16 v70, v28, v29 op_sel:[1,1,0]
    v_pack_b32_f16 v71, v30, v31 op_sel:[1,1,0]
    v_exp_f32 v32, v32
    v_exp_f32 v33, v33
    v_mfma_f32_32x32x16_bf16 v[48:63], v[148:151], v[68:71], v[48:63]
    ds_read_b128 v[144:147], v158 offset:15456
    ds_read_b128 v[148:151], v159 offset:15456
    v_exp_f32 v34, v34
    v_exp_f32 v35, v35
    v_exp_f32 v36, v36
    v_exp_f32 v37, v37
    v_pack_b32_f16 v64, v32, v33 op_sel:[1,1,0]
    v_pack_b32_f16 v65, v34, v35 op_sel:[1,1,0]
    s_waitcnt lgkmcnt(2)
    v_mfma_f32_32x32x8_bf16 v[16:31], v[152:153], v[154:155], 0
    v_exp_f32 v38, v38
    v_exp_f32 v39, v39
    v_exp_f32 v40, v40
    v_exp_f32 v41, v41
    v_pack_b32_f16 v66, v36, v37 op_sel:[1,1,0]
    v_pack_b32_f16 v67, v38, v39 op_sel:[1,1,0]
    v_mfma_f32_32x32x16_bf16 v[16:31], v[72:75], v[76:79], v[16:31]
    ds_read_b128 v[72:75], v156 offset:20608
    ds_read_b32 v152, v157 offset:20608
    v_exp_f32 v42, v42
    v_exp_f32 v43, v43
    v_exp_f32 v44, v44
    v_exp_f32 v45, v45
    v_pack_b32_f16 v68, v40, v41 op_sel:[1,1,0]
    v_pack_b32_f16 v69, v42, v43 op_sel:[1,1,0]
    s_waitcnt lgkmcnt(2)
    v_mfma_f32_32x32x16_bf16 v[48:63], v[144:147], v[64:67], v[48:63]
    v_exp_f32 v46, v46
    v_exp_f32 v47, v47
    v_pack_b32_f16 v70, v44, v45 op_sel:[1,1,0]
    v_pack_b32_f16 v71, v46, v47 op_sel:[1,1,0]
    v_exp_f32 v16, v16
    v_exp_f32 v17, v17
    v_mfma_f32_32x32x16_bf16 v[48:63], v[148:151], v[68:71], v[48:63]
    ds_read_b128 v[144:147], v158 offset:18032
    ds_read_b128 v[148:151], v159 offset:18032
    v_exp_f32 v18, v18
    v_exp_f32 v19, v19
    v_exp_f32 v20, v20
    v_exp_f32 v21, v21
    v_pack_b32_f16 v64, v16, v17 op_sel:[1,1,0]
    v_pack_b32_f16 v65, v18, v19 op_sel:[1,1,0]
    s_waitcnt lgkmcnt(2)
    v_mfma_f32_32x32x8_bf16 v[32:47], v[152:153], v[154:155], 0
    v_exp_f32 v22, v22
    v_exp_f32 v23, v23
    v_exp_f32 v24, v24
    v_exp_f32 v25, v25
    v_pack_b32_f16 v66, v20, v21 op_sel:[1,1,0]
    v_pack_b32_f16 v67, v22, v23 op_sel:[1,1,0]
    v_mfma_f32_32x32x16_bf16 v[32:47], v[72:75], v[76:79], v[32:47]
    ds_read_b128 v[72:75], v156 offset:23184
    ds_read_b32 v152, v157 offset:23184
    v_exp_f32 v26, v26
    v_exp_f32 v27, v27
    v_exp_f32 v28, v28
    v_exp_f32 v29, v29
    v_pack_b32_f16 v68, v24, v25 op_sel:[1,1,0]
    v_pack_b32_f16 v69, v26, v27 op_sel:[1,1,0]
    s_waitcnt lgkmcnt(2)
    v_mfma_f32_32x32x16_bf16 v[48:63], v[144:147], v[64:67], v[48:63]
    v_exp_f32 v30, v30
    v_exp_f32 v31, v31
    v_pack_b32_f16 v70, v28, v29 op_sel:[1,1,0]
    v_pack_b32_f16 v71, v30, v31 op_sel:[1,1,0]
    v_exp_f32 v32, v32
    v_exp_f32 v33, v33
    v_mfma_f32_32x32x16_bf16 v[48:63], v[148:151], v[68:71], v[48:63]
    ds_read_b128 v[144:147], v158 offset:20608
    ds_read_b128 v[148:151], v159 offset:20608
    v_exp_f32 v34, v34
    v_exp_f32 v35, v35
    v_exp_f32 v36, v36
    v_exp_f32 v37, v37
    v_pack_b32_f16 v64, v32, v33 op_sel:[1,1,0]
    v_pack_b32_f16 v65, v34, v35 op_sel:[1,1,0]
    s_waitcnt lgkmcnt(2)
    v_mfma_f32_32x32x8_bf16 v[16:31], v[152:153], v[154:155], 0
    v_exp_f32 v38, v38
    v_exp_f32 v39, v39
    v_exp_f32 v40, v40
    v_exp_f32 v41, v41
    v_pack_b32_f16 v66, v36, v37 op_sel:[1,1,0]
    v_pack_b32_f16 v67, v38, v39 op_sel:[1,1,0]
    v_mfma_f32_32x32x16_bf16 v[16:31], v[72:75], v[76:79], v[16:31]
    ds_read_b128 v[72:75], v156 offset:25760
    ds_read_b32 v152, v157 offset:25760
    v_exp_f32 v42, v42
    v_exp_f32 v43, v43
    v_exp_f32 v44, v44
    v_exp_f32 v45, v45
    v_pack_b32_f16 v68, v40, v41 op_sel:[1,1,0]
    v_pack_b32_f16 v69, v42, v43 op_sel:[1,1,0]
    s_waitcnt lgkmcnt(2)
    v_mfma_f32_32x32x16_bf16 v[48:63], v[144:147], v[64:67], v[48:63]
    v_exp_f32 v46, v46
    v_exp_f32 v47, v47
    v_pack_b32_f16 v70, v44, v45 op_sel:[1,1,0]
    v_pack_b32_f16 v71, v46, v47 op_sel:[1,1,0]
    v_exp_f32 v16, v16
    v_exp_f32 v17, v17
    v_mfma_f32_32x32x16_bf16 v[48:63], v[148:151], v[68:71], v[48:63]
    ds_read_b128 v[144:147], v158 offset:23184
    ds_read_b128 v[148:151], v159 offset:23184
    v_exp_f32 v18, v18
    v_exp_f32 v19, v19
    v_exp_f32 v20, v20
    v_exp_f32 v21, v21
    v_pack_b32_f16 v64, v16, v17 op_sel:[1,1,0]
    v_pack_b32_f16 v65, v18, v19 op_sel:[1,1,0]
    s_waitcnt lgkmcnt(2)
    v_mfma_f32_32x32x8_bf16 v[32:47], v[152:153], v[154:155], 0
    v_exp_f32 v22, v22
    v_exp_f32 v23, v23
    v_exp_f32 v24, v24
    v_exp_f32 v25, v25
    v_pack_b32_f16 v66, v20, v21 op_sel:[1,1,0]
    v_pack_b32_f16 v67, v22, v23 op_sel:[1,1,0]
    v_mfma_f32_32x32x16_bf16 v[32:47], v[72:75], v[76:79], v[32:47]
    ds_read_b128 v[72:75], v156 offset:28336
    ds_read_b32 v152, v157 offset:28336
    v_exp_f32 v26, v26
    v_exp_f32 v27, v27
    v_exp_f32 v28, v28
    v_exp_f32 v29, v29
    v_pack_b32_f16 v68, v24, v25 op_sel:[1,1,0]
    v_pack_b32_f16 v69, v26, v27 op_sel:[1,1,0]
    s_waitcnt lgkmcnt(2)
    v_mfma_f32_32x32x16_bf16 v[48:63], v[144:147], v[64:67], v[48:63]
    v_exp_f32 v30, v30
    v_exp_f32 v31, v31
    v_pack_b32_f16 v70, v28, v29 op_sel:[1,1,0]
    v_pack_b32_f16 v71, v30, v31 op_sel:[1,1,0]
    v_exp_f32 v32, v32
    v_exp_f32 v33, v33
    v_mfma_f32_32x32x16_bf16 v[48:63], v[148:151], v[68:71], v[48:63]
    ds_read_b128 v[144:147], v158 offset:25760
    ds_read_b128 v[148:151], v159 offset:25760
    v_exp_f32 v34, v34
    v_exp_f32 v35, v35
    v_exp_f32 v36, v36
    v_exp_f32 v37, v37
    v_pack_b32_f16 v64, v32, v33 op_sel:[1,1,0]
    v_pack_b32_f16 v65, v34, v35 op_sel:[1,1,0]
    s_waitcnt lgkmcnt(2)
    v_mfma_f32_32x32x8_bf16 v[16:31], v[152:153], v[154:155], 0
    v_exp_f32 v38, v38
    v_exp_f32 v39, v39
    v_exp_f32 v40, v40
    v_exp_f32 v41, v41
    v_pack_b32_f16 v66, v36, v37 op_sel:[1,1,0]
    v_pack_b32_f16 v67, v38, v39 op_sel:[1,1,0]
    v_mfma_f32_32x32x16_bf16 v[16:31], v[72:75], v[76:79], v[16:31]
    ds_read_b128 v[72:75], v156 offset:30912
    ds_read_b32 v152, v157 offset:30912
    v_exp_f32 v42, v42
    v_exp_f32 v43, v43
    v_exp_f32 v44, v44
    v_exp_f32 v45, v45
    v_pack_b32_f16 v68, v40, v41 op_sel:[1,1,0]
    v_pack_b32_f16 v69, v42, v43 op_sel:[1,1,0]
    s_waitcnt lgkmcnt(2)
    v_mfma_f32_32x32x16_bf16 v[48:63], v[144:147], v[64:67], v[48:63]
    v_exp_f32 v46, v46
    v_exp_f32 v47, v47
    v_pack_b32_f16 v70, v44, v45 op_sel:[1,1,0]
    v_pack_b32_f16 v71, v46, v47 op_sel:[1,1,0]
    v_exp_f32 v16, v16
    v_exp_f32 v17, v17
    v_mfma_f32_32x32x16_bf16 v[48:63], v[148:151], v[68:71], v[48:63]
    ds_read_b128 v[144:147], v158 offset:28336
    ds_read_b128 v[148:151], v159 offset:28336
    v_exp_f32 v18, v18
    v_exp_f32 v19, v19
    v_exp_f32 v20, v20
    v_exp_f32 v21, v21
    v_pack_b32_f16 v64, v16, v17 op_sel:[1,1,0]
    v_pack_b32_f16 v65, v18, v19 op_sel:[1,1,0]
    s_waitcnt lgkmcnt(2)
    v_mfma_f32_32x32x8_bf16 v[32:47], v[152:153], v[154:155], 0
    v_exp_f32 v22, v22
    v_exp_f32 v23, v23
    v_exp_f32 v24, v24
    v_exp_f32 v25, v25
    v_pack_b32_f16 v66, v20, v21 op_sel:[1,1,0]
    v_pack_b32_f16 v67, v22, v23 op_sel:[1,1,0]
    v_mfma_f32_32x32x16_bf16 v[32:47], v[72:75], v[76:79], v[32:47]
    ds_read_b128 v[72:75], v156 offset:33488
    ds_read_b32 v152, v157 offset:33488
    v_exp_f32 v26, v26
    v_exp_f32 v27, v27
    v_exp_f32 v28, v28
    v_exp_f32 v29, v29
    v_pack_b32_f16 v68, v24, v25 op_sel:[1,1,0]
    v_pack_b32_f16 v69, v26, v27 op_sel:[1,1,0]
    s_waitcnt lgkmcnt(2)
    v_mfma_f32_32x32x16_bf16 v[48:63], v[144:147], v[64:67], v[48:63]
    v_exp_f32 v30, v30
    v_exp_f32 v31, v31
    v_pack_b32_f16 v70, v28, v29 op_sel:[1,1,0]
    v_pack_b32_f16 v71, v30, v31 op_sel:[1,1,0]
    v_add_u32 v156, 30912, v156
    v_add_u32 v157, 30912, v157
    v_add_u32 v158, 30912, v158
    v_add_u32 v159, 30912, v159
    s_add_u32 s46, s46, 6
    s_cmp_gt_u32 s46, 32
    s_cbranch_scc1 Lattn_tail
    s_mov_b64 exec, 1
    ds_add_u32 v160, v14 offset:0
    s_mov_b64 exec, -1
    v_add_u32 v160, 4, v160
    s_branch Lattn_loopb
Lattn_slow3:
Lw45:
    ds_read_b32 v13, v15 offset:32
    s_waitcnt lgkmcnt(0)
    v_readfirstlane_b32 s47, v13
    s_cmp_ge_u32 s47, s46
    s_cbranch_scc1 Lwd46
    s_sub_u32 s92, s92, 1
    s_cbranch_scc1 Lwd46
    s_sleep 1
    s_branch Lw45
Lwd46:
    s_branch Lattn_cont3
Lattn_slow7:
Lw47:
    ds_read_b32 v13, v15 offset:32
    s_waitcnt lgkmcnt(0)
    v_readfirstlane_b32 s47, v13
    s_cmp_ge_u32 s47, s46
    s_cbranch_scc1 Lwd48
    s_sub_u32 s92, s92, 1
    s_cbranch_scc1 Lwd48
    s_sleep 1
    s_branch Lw47
Lwd48:
    s_branch Lattn_cont7
Lattn_slow11:
Lw49:
    ds_read_b32 v13, v15 offset:32
    s_waitcnt lgkmcnt(0)
    v_readfirstlane_b32 s47, v13
    s_cmp_ge_u32 s47, s46
    s_cbranch_scc1 Lwd50
    s_sub_u32 s92, s92, 1
    s_cbranch_scc1 Lwd50
    s_sleep 1
    s_branch Lw49
Lwd50:
    s_branch Lattn_cont11
Lattn_tail:
    v_exp_f32 v32, v32
    v_exp_f32 v33, v33
    v_mfma_f32_32x32x16_bf16 v[48:63], v[148:151], v[68:71], v[48:63]
    ds_read_b128 v[144:147], v158 offset:0
    ds_read_b128 v[148:151], v159 offset:0
    v_exp_f32 v34, v34
    v_exp_f32 v35, v35
    v_exp_f32 v36, v36
    v_exp_f32 v37, v37
    v_pack_b32_f16 v64, v32, v33 op_sel:[1,1,0]
    v_pack_b32_f16 v65, v34, v35 op_sel:[1,1,0]
    s_waitcnt lgkmcnt(2)
    v_mfma_f32_32x32x8_bf16 v[16:31], v[152:153], v[154:155], 0
    v_exp_f32 v38, v38
    v_exp_f32 v39, v39
    v_exp_f32 v40, v40
    v_exp_f32 v41, v41
    v_pack_b32_f16 v66, v36, v37 op_sel:[1,1,0]
    v_pack_b32_f16 v67, v38, v39 op_sel:[1,1,0]
    v_mfma_f32_32x32x16_bf16 v[16:31], v[72:75], v[76:79], v[16:31]
    ds_read_b128 v[72:75], v156 offset:5152
    ds_read_b32 v152, v157 offset:5152
    v_exp_f32 v42, v42
    v_exp_f32 v43, v43
    v_exp_f32 v44, v44
    v_exp_f32 v45, v45
    v_pack_b32_f16 v68, v40, v41 op_sel:[1,1,0]
    v_pack_b32_f16 v69, v42, v43 op_sel:[1,1,0]
    s_waitcnt lgkmcnt(2)
    v_mfma_f32_32x32x16_bf16 v[48:63], v[144:147], v[64:67], v[48:63]
    v_exp_f32 v46, v46
    v_exp_f32 v47, v47
    v_pack_b32_f16 v70, v44, v45 op_sel:[1,1,0]
    v_pack_b32_f16 v71, v46, v47 op_sel:[1,1,0]
    v_exp_f32 v16, v16
    v_exp_f32 v17, v17
    v_mfma_f32_32x32x16_bf16 v[48:63], v[148:151], v[68:71], v[48:63]
    ds_read_b128 v[144:147], v158 offset:2576
    ds_read_b128 v[148:151], v159 offset:2576
    v_exp_f32 v18, v18
    v_exp_f32 v19, v19
    v_exp_f32 v20, v20
    v_exp_f32 v21, v21
    v_pack_b32_f16 v64, v16, v17 op_sel:[1,1,0]
    v_pack_b32_f16 v65, v18, v19 op_sel:[1,1,0]
    s_waitcnt lgkmcnt(2)
    v_mfma_f32_32x32x8_bf16 v[32:47], v[152:153], v[154:155], 0
    v_exp_f32 v22, v22
    v_exp_f32 v23, v23
    v_exp_f32 v24, v24
    v_exp_f32 v25, v25
    v_pack_b32_f16 v66, v20, v21 op_sel:[1,1,0]
    v_pack_b32_f16 v67, v22, v23 op_sel:[1,1,0]
    v_mfma_f32_32x32x16_bf16 v[32:47], v[72:75], v[76:79], v[32:47]
    v_exp_f32 v26, v26
    v_exp_f32 v27, v27
    v_exp_f32 v28, v28
    v_exp_f32 v29, v29
    v_pack_b32_f16 v68, v24, v25 op_sel:[1,1,0]
    v_pack_b32_f16 v69, v26, v27 op_sel:[1,1,0]
    s_waitcnt lgkmcnt(0)
    v_mfma_f32_32x32x16_bf16 v[48:63], v[144:147], v[64:67], v[48:63]
    v_exp_f32 v30, v30
    v_exp_f32 v31, v31
    v_pack_b32_f16 v70, v28, v29 op_sel:[1,1,0]
    v_pack_b32_f16 v71, v30, v31 op_sel:[1,1,0]
    v_exp_f32 v32, v32
    v_exp_f32 v33, v33
    v_mfma_f32_32x32x16_bf16 v[48:63], v[148:151], v[68:71], v[48:63]
    ds_read_b128 v[144:147], v158 offset:5152
    ds_read_b128 v[148:151], v159 offset:5152
    v_exp_f32 v34, v34
    v_exp_f32 v35, v35
    v_exp_f32 v36, v36
    v_exp_f32 v37, v37
    v_pack_b32_f16 v64, v32, v33 op_sel:[1,1,0]
    v_pack_b32_f16 v65, v34, v35 op_sel:[1,1,0]
    v_exp_f32 v38, v38
    v_exp_f32 v39, v39
    v_exp_f32 v40, v40
    v_exp_f32 v41, v41
    v_pack_b32_f16 v66, v36, v37 op_sel:[1,1,0]
    v_pack_b32_f16 v67, v38, v39 op_sel:[1,1,0]
    v_exp_f32 v42, v42
    v_exp_f32 v43, v43
    v_exp_f32 v44, v44
    v_exp_f32 v45, v45
    v_pack_b32_f16 v68, v40, v41 op_sel:[1,1,0]
    v_pack_b32_f16 v69, v42, v43 op_sel:[1,1,0]
    s_waitcnt lgkmcnt(0)
    v_mfma_f32_32x32x16_bf16 v[48:63], v[144:147], v[64:67], v[48:63]
    v_exp_f32 v46, v46
    v_exp_f32 v47, v47
    v_pack_b32_f16 v70, v44, v45 op_sel:[1,1,0]
    v_pack_b32_f16 v71, v46, v47 op_sel:[1,1,0]
    s_nop 1
    v_mfma_f32_32x32x16_bf16 v[48:63], v[148:151], v[68:71], v[48:63]
    s_lshl2_add_u32 s48, s5, s99
    s_lshl_b32 s44, s4, 6
    s_bfe_u32 s45, s3, 0x10001
    s_lshl_b32 s45, s45, 5
    s_add_u32 s44, s44, s45
    v_and_b32 v99, 31, v0
    v_add_u32 v99, s44, v99
    v_lshrrev_b32 v100, 5, v0
    v_lshlrev_b32 v100, 15, v100
    v_lshl_add_u32 v100, v99, 4, v100
    s_lshl_b32 s52, s48, 16
    s_add_u32 s52, s52, 16777216
    s_lshl_b32 s53, s48, 14
    s_add_u32 s53, s53, 18874368
    v_lshlrev_b32 v101, 3, v99
Lattn_chk:
    v_mov_b32 v102, v56
    v_mov_b32 v103, v56
    s_mov_b32 s44, 0x30800000
    s_mov_b32 s45, 0x5d800000
    v_permlane32_swap_b32 v102, v103
    s_nop 1
    v_cmp_le_f32 s[46:47], s44, v103
    v_cmp_ge_f32 s[50:51], s45, v103
    v_rcp_f32 v98, v103
    s_and_b64 s[46:47], s[46:47], s[50:51]
    s_cmp_eq_u64 s[46:47], -1
    s_cbranch_scc0 Lfallback
Lattn_epi:
    ds_read_b32 v161, v15 offset:60
    v_mul_f32 v98, v125, v98
    v_mul_f32 v48, v98, v48
    v_mul_f32 v49, v98, v49
    v_mul_f32 v50, v98, v50
    v_mul_f32 v51, v98, v51
    v_mul_f32 v52, v98, v52
    v_mul_f32 v53, v98, v53
    v_mul_f32 v54, v98, v54
    v_mul_f32 v55, v98, v55
    v_mul_f32 v56, v98, v56
    v_mul_f32 v57, v98, v57
    v_mul_f32 v58, v98, v58
    v_mul_f32 v59, v98, v59
    v_cvt_pk_bf16_f32 v64, v48, v49
    v_cvt_pk_bf16_f32 v65, v50, v51
    v_cvt_pk_bf16_f32 v66, v52, v53
    v_cvt_pk_bf16_f32 v67, v54, v55
    v_cvt_pk_bf16_f32 v68, v56, v57
    v_cvt_pk_bf16_f32 v69, v58, v59
    s_nop 0
    v_permlane32_swap_b32 v64, v66
    v_permlane32_swap_b32 v65, v67
    s_waitcnt lgkmcnt(0)
    v_cmp_eq_u32 vcc, 0, v161
    s_cbranch_vccnz Lattn_wt
    buffer_store_dwordx4 v[64:67], v100, s[24:27], s52 offen
    s_mov_b32 exec_hi, 0
    buffer_store_dwordx2 v[68:69], v101, s[24:27], s53 offen
Lattn_std:
    s_mov_b64 exec, 1
    ds_add_u32 v15, v14 offset:56
    s_mov_b64 exec, -1
    s_waitcnt lgkmcnt(0)
    s_wakeup
    s_endpgm
Lattn_wt:
    buffer_store_dwordx4 v[64:67], v100, s[24:27], s52 offen sc1
    s_mov_b32 exec_hi, 0
    buffer_store_dwordx2 v[68:69], v101, s[24:27], s53 offen sc1
    s_branch Lattn_std
Lprep2:
    s_setprio 1
Lw51:
    ds_read_b32 v13, v15 offset:40
    s_waitcnt lgkmcnt(0)
    v_readfirstlane_b32 s32, v13
    s_cmp_ge_u32 s32, 1
    s_cbranch_scc1 Lwd52
    s_sub_u32 s92, s92, 1
    s_cbranch_scc1 Lwd52
    s_sleep 1
    s_branch Lw51
Lwd52:
    v_mov_b32 v8, s32
    s_cmp_lg_u32 s62, 0
    s_cbranch_scc1 Lp2_fold
    s_waitcnt vmcnt(0)
    s_branch Lp2_rep
Lp2_fold:
    s_waitcnt vmcnt(9)
    s_mov_b32 s44, 0xffff0000
    v_lshlrev_b32 v16, 16, v97
    v_lshlrev_b32 v20, 16, v115
    v_lshlrev_b32 v17, 16, v101
    v_lshlrev_b32 v21, 16, v119
    v_lshlrev_b32 v18, 16, v105
    v_lshlrev_b32 v22, 16, v123
    v_lshlrev_b32 v19, 16, v109
    v_lshlrev_b32 v23, 16, v127
    v_add_f32 v24, v16, v20
    v_sub_f32 v28, v16, v20
    v_add_f32 v25, v17, v21
    v_sub_f32 v29, v17, v21
    v_add_f32 v26, v18, v22
    v_sub_f32 v30, v18, v22
    v_add_f32 v27, v19, v23
    v_sub_f32 v31, v19, v23
    v_add_f32 v16, v24, v27
    v_add_f32 v17, v25, v26
    v_sub_f32 v18, v28, v31
    v_sub_f32 v19, v30, v29
    v_add_f32 v32, v16, v17
    v_sub_f32 v33, v16, v17
    v_add_f32 v34, v18, v19
    v_sub_f32 v35, v18, v19
    v_and_b32 v16, s44, v97
    v_and_b32 v20, s44, v114
    v_and_b32 v17, s44, v101
    v_and_b32 v21, s44, v118
    v_and_b32 v18, s44, v105
    v_and_b32 v22, s44, v122
    v_and_b32 v19, s44, v109
    v_and_b32 v23, s44, v126
    v_add_f32 v24, v16, v20
    v_sub_f32 v28, v16, v20
    v_add_f32 v25, v17, v21
    v_sub_f32 v29, v17, v21
    v_add_f32 v26, v18, v22
    v_sub_f32 v30, v18, v22
    v_add_f32 v27, v19, v23
    v_sub_f32 v31, v19, v23
    v_add_f32 v16, v24, v27
    v_add_f32 v17, v25, v26
    v_sub_f32 v18, v28, v31
    v_sub_f32 v19, v30, v29
    v_add_f32 v36, v16, v17
    v_sub_f32 v37, v16, v17
    v_add_f32 v38, v18, v19
    v_sub_f32 v39, v18, v19
    v_cvt_pk_bf16_f32 v49, v32, v36
    v_cvt_pk_bf16_f32 v53, v33, v37
    v_cvt_pk_bf16_f32 v57, v34, v38
    v_cvt_pk_bf16_f32 v61, v35, v39
    v_lshlrev_b32 v16, 16, v98
    v_lshlrev_b32 v20, 16, v114
    v_lshlrev_b32 v17, 16, v102
    v_lshlrev_b32 v21, 16, v118
    v_lshlrev_b32 v18, 16, v106
    v_lshlrev_b32 v22, 16, v122
    v_lshlrev_b32 v19, 16, v110
    v_lshlrev_b32 v23, 16, v126
    v_add_f32 v24, v16, v20
    v_sub_f32 v28, v16, v20
    v_add_f32 v25, v17, v21
    v_sub_f32 v29, v17, v21
    v_add_f32 v26, v18, v22
    v_sub_f32 v30, v18, v22
    v_add_f32 v27, v19, v23
    v_sub_f32 v31, v19, v23
    v_add_f32 v16, v24, v27
    v_add_f32 v17, v25, v26
    v_sub_f32 v18, v28, v31
    v_sub_f32 v19, v30, v29
    v_add_f32 v32, v16, v17
    v_sub_f32 v33, v16, v17
    v_add_f32 v34, v18, v19
    v_sub_f32 v35, v18, v19
    v_and_b32 v16, s44, v98
    v_and_b32 v20, s44, v113
    v_and_b32 v17, s44, v102
    v_and_b32 v21, s44, v117
    v_and_b32 v18, s44, v106
    v_and_b32 v22, s44, v121
    v_and_b32 v19, s44, v110
    v_and_b32 v23, s44, v125
    v_add_f32 v24, v16, v20
    v_sub_f32 v28, v16, v20
    v_add_f32 v25, v17, v21
    v_sub_f32 v29, v17, v21
    v_add_f32 v26, v18, v22
    v_sub_f32 v30, v18, v22
    v_add_f32 v27, v19, v23
    v_sub_f32 v31, v19, v23
    v_add_f32 v16, v24, v27
    v_add_f32 v17, v25, v26
    v_sub_f32 v18, v28, v31
    v_sub_f32 v19, v30, v29
    v_add_f32 v36, v16, v17
    v_sub_f32 v37, v16, v17
    v_add_f32 v38, v18, v19
    v_sub_f32 v39, v18, v19
    v_cvt_pk_bf16_f32 v50, v32, v36
    v_cvt_pk_bf16_f32 v54, v33, v37
    v_cvt_pk_bf16_f32 v58, v34, v38
    v_cvt_pk_bf16_f32 v62, v35, v39
    v_lshlrev_b32 v16, 16, v99
    v_lshlrev_b32 v20, 16, v113
    v_lshlrev_b32 v17, 16, v103
    v_lshlrev_b32 v21, 16, v117
    v_lshlrev_b32 v18, 16, v107
    v_lshlrev_b32 v22, 16, v121
    v_lshlrev_b32 v19, 16, v111
    v_lshlrev_b32 v23, 16, v125
    v_add_f32 v24, v16, v20
    v_sub_f32 v28, v16, v20
    v_add_f32 v25, v17, v21
    v_sub_f32 v29, v17, v21
    v_add_f32 v26, v18, v22
    v_sub_f32 v30, v18, v22
    v_add_f32 v27, v19, v23
    v_sub_f32 v31, v19, v23
    v_add_f32 v16, v24, v27
    v_add_f32 v17, v25, v26
    v_sub_f32 v18, v28, v31
    v_sub_f32 v19, v30, v29
    v_add_f32 v32, v16, v17
    v_sub_f32 v33, v16, v17
    v_add_f32 v34, v18, v19
    v_sub_f32 v35, v18, v19
    v_and_b32 v16, s44, v99
    v_and_b32 v20, s44, v112
    v_and_b32 v17, s44, v103
    v_and_b32 v21, s44, v116
    v_and_b32 v18, s44, v107
    v_and_b32 v22, s44, v120
    v_and_b32 v19, s44, v111
    v_and_b32 v23, s44, v124
    v_add_f32 v24, v16, v20
    v_sub_f32 v28, v16, v20
    v_add_f32 v25, v17, v21
    v_sub_f32 v29, v17, v21
    v_add_f32 v26, v18, v22
    v_sub_f32 v30, v18, v22
    v_add_f32 v27, v19, v23
    v_sub_f32 v31, v19, v23
    v_add_f32 v16, v24, v27
    v_add_f32 v17, v25, v26
    v_sub_f32 v18, v28, v31
    v_sub_f32 v19, v30, v29
    v_add_f32 v36, v16, v17
    v_sub_f32 v37, v16, v17
    v_add_f32 v38, v18, v19
    v_sub_f32 v39, v18, v19
    v_cvt_pk_bf16_f32 v51, v32, v36
    v_cvt_pk_bf16_f32 v55, v33, v37
    v_cvt_pk_bf16_f32 v59, v34, v38
    v_cvt_pk_bf16_f32 v63, v35, v39
    s_waitcnt vmcnt(5)
    v_lshlrev_b32 v16, 16, v96
    v_lshlrev_b32 v20, 16, v128
    v_lshlrev_b32 v17, 16, v100
    v_lshlrev_b32 v21, 16, v129
    v_lshlrev_b32 v18, 16, v104
    v_lshlrev_b32 v22, 16, v130
    v_lshlrev_b32 v19, 16, v108
    v_lshlrev_b32 v23, 16, v131
    v_add_f32 v24, v16, v20
    v_sub_f32 v28, v16, v20
    v_add_f32 v25, v17, v21
    v_sub_f32 v29, v17, v21
    v_add_f32 v26, v18, v22
    v_sub_f32 v30, v18, v22
    v_add_f32 v27, v19, v23
    v_sub_f32 v31, v19, v23
    v_add_f32 v16, v24, v27
    v_add_f32 v17, v25, v26
    v_sub_f32 v18, v28, v31
    v_sub_f32 v19, v30, v29
    v_add_f32 v32, v16, v17
    v_sub_f32 v33, v16, v17
    v_add_f32 v34, v18, v19
    v_sub_f32 v35, v18, v19
    v_and_b32 v16, s44, v96
    v_and_b32 v20, s44, v115
    v_and_b32 v17, s44, v100
    v_and_b32 v21, s44, v119
    v_and_b32 v18, s44, v104
    v_and_b32 v22, s44, v123
    v_and_b32 v19, s44, v108
    v_and_b32 v23, s44, v127
    v_add_f32 v24, v16, v20
    v_sub_f32 v28, v16, v20
    v_add_f32 v25, v17, v21
    v_sub_f32 v29, v17, v21
    v_add_f32 v26, v18, v22
    v_sub_f32 v30, v18, v22
    v_add_f32 v27, v19, v23
    v_sub_f32 v31, v19, v23
    v_add_f32 v16, v24, v27
    v_add_f32 v17, v25, v26
    v_sub_f32 v18, v28, v31
    v_sub_f32 v19, v30, v29
    v_add_f32 v36, v16, v17
    v_sub_f32 v37, v16, v17
    v_add_f32 v38, v18, v19
    v_sub_f32 v39, v18, v19
    v_cvt_pk_bf16_f32 v48, v32, v36
    v_cvt_pk_bf16_f32 v52, v33, v37
    v_cvt_pk_bf16_f32 v56, v34, v38
    v_cvt_pk_bf16_f32 v60, v35, v39
    ds_bpermute_b32 v64, v141, v48
    ds_bpermute_b32 v65, v141, v49
    ds_bpermute_b32 v66, v141, v50
    ds_bpermute_b32 v67, v141, v51
    ds_bpermute_b32 v68, v141, v52
    ds_bpermute_b32 v69, v141, v53
    ds_bpermute_b32 v70, v141, v54
    ds_bpermute_b32 v71, v141, v55
    ds_bpermute_b32 v72, v141, v56
    ds_bpermute_b32 v73, v141, v57
    ds_bpermute_b32 v74, v141, v58
    ds_bpermute_b32 v75, v141, v59
    ds_bpermute_b32 v76, v141, v60
    ds_bpermute_b32 v77, v141, v61
    ds_bpermute_b32 v78, v141, v62
    ds_bpermute_b32 v79, v141, v63
    s_bitcmp1_b32 s91, 30
    s_cbranch_scc1 Lp2_nomid
    v_lshlrev_b32 v16, 16, v112
    v_lshlrev_b32 v17, 16, v116
    v_lshlrev_b32 v18, 16, v120
    v_lshlrev_b32 v19, 16, v124
    v_add_f32 v16, v16, v19
    v_add_f32 v17, v17, v18
    v_add_f32 v18, v16, v17
    v_sub_f32 v19, v16, v17
    v_cvt_pk_bf16_f32 v16, v18, v19
Lp2_nomid:
    buffer_store_dword v16, v143, s[24:27], s91 offen sc1
    s_waitcnt lgkmcnt(12)
    buffer_store_dwordx4 v[64:67], v142, s[24:27], s47 offen sc1
    s_add_u32 s47, s47, 348160
    s_waitcnt lgkmcnt(8)
    buffer_store_dwordx4 v[68:71], v142, s[24:27], s47 offen sc1
    s_add_u32 s47, s47, 348160
    s_waitcnt lgkmcnt(4)
    buffer_store_dwordx4 v[72:75], v142, s[24:27], s47 offen sc1
    s_add_u32 s47, s47, 348160
    s_waitcnt lgkmcnt(0)
    buffer_store_dwordx4 v[76:79], v142, s[24:27], s47 offen sc1
    s_waitcnt vmcnt(5)
Lp2_rep:
    ds_bpermute_b32 v80, v141, v144
    ds_bpermute_b32 v81, v141, v145
    ds_bpermute_b32 v82, v141, v146
    ds_bpermute_b32 v83, v141, v147
    ds_bpermute_b32 v84, v141, v148
    ds_bpermute_b32 v85, v141, v149
    ds_bpermute_b32 v86, v141, v150
    ds_bpermute_b32 v87, v141, v151
    ds_bpermute_b32 v88, v141, v152
    ds_bpermute_b32 v89, v141, v153
    ds_bpermute_b32 v90, v141, v154
    ds_bpermute_b32 v91, v141, v155
    ds_bpermute_b32 v92, v141, v156
    ds_bpermute_b32 v93, v141, v157
    ds_bpermute_b32 v94, v141, v158
    ds_bpermute_b32 v95, v141, v159
    s_waitcnt lgkmcnt(12)
    buffer_store_dwordx4 v[80:83], v142, s[24:27], s56 offen offset:0 sc1
    s_waitcnt lgkmcnt(8)
    buffer_store_dwordx4 v[84:87], v142, s[24:27], s56 offen offset:128 sc1
    s_waitcnt lgkmcnt(4)
    buffer_store_dwordx4 v[88:91], v142, s[24:27], s56 offen offset:256 sc1
    s_waitcnt lgkmcnt(0)
    buffer_store_dwordx4 v[92:95], v142, s[24:27], s56 offen offset:384 sc1
    s_add_u32 s56, s56, 4096
    s_add_u32 s56, s56, s57
    buffer_store_dwordx4 v[160:163], v1, s[24:27], s56 offen sc1
    s_waitcnt vmcnt(5)
    s_mov_b64 exec, 1
    buffer_store_dword v8, v139, s[24:27], 0 offen sc1
    s_mov_b64 exec, -1
    s_setprio 3
    s_lshr_b32 s45, s60, 1
    s_bitcmp1_b32 s60, 0
    s_cbranch_scc1 Ls2_set
    s_cmp_ge_u32 s45, 42
    s_cbranch_scc1 Ls1_x
    s_mov_b32 s63, 1
    s_cmp_ge_u32 s45, 21
    s_cselect_b32 s54, 8, 0
    s_cselect_b32 s46, 21, 0
    s_add_u32 s54, s54, s6
    s_sub_u32 s46, s45, s46
    s_branch Ls1_go
Ls1_x:
    s_movk_i32 s54, 16
    s_mul_i32 s46, s6, 3
    s_add_u32 s46, s46, s45
    s_sub_u32 s46, s46, 42
    s_cmp_lt_u32 s45, 45
    s_cselect_b32 s63, 1, 0
    s_cmp_lt_u32 s46, 21
    s_cselect_b32 s63, s63, 0
    s_cselect_b32 s46, s46, 0
Ls1_go:
    s_cmp_ge_u32 s46, 11
    s_cselect_b32 s48, 34, 0
    s_cselect_b32 s44, 11, 0
    s_add_u32 s48, s48, s54
    s_mul_i32 s48, s48, 20480
    s_add_u32 s48, s48, 1048576
    s_add_u32 s47, s48, 348160
    s_mul_i32 s49, s46, 20480
    s_add_u32 s49, s49, 4194304
    s_lshl_b32 s50, s54, 7
    s_add_u32 s50, s50, 983040
    s_cmp_ge_u32 s46, 11
    s_cselect_b32 s50, 1073741824, s50
    s_mul_i32 s56, s46, 17
    s_add_u32 s56, s56, s54
    s_lshl_b32 s56, s56, 7
    s_add_u32 s56, s56, 720896
    s_mul_i32 s45, s54, 2560
    s_add_u32 s45, s45, 524288
    s_add_u32 s44, s44, s46
    s_mul_i32 s44, s44, 17
    s_add_u32 s44, s44, s54
    s_lshl_b32 s54, s44, 11
    s_add_u32 s54, s54, 8388608
    s_add_u32 s55, s54, 382976
    s_mul_i32 s46, s46, 640
    s_add_u32 s46, s46, 620032
    s_mov_b32 s44, 20
    s_mov_b32 s52, 0x1ffffff
    s_mov_b32 s53, 0
    s_mov_b32 s62, 1
    s_mov_b32 s59, 16
    s_branch Ls_set
Ls2_set:
    s_mul_i32 s54, s45, 47
    s_lshr_b32 s54, s54, 9
    s_mul_i32 s46, s54, 11
    s_sub_u32 s46, s45, s46
    s_lshl2_add_u32 s54, s6, s54
    s_mov_b32 s63, 1
    s_cmp_lt_u32 s45, 44
    s_cbranch_scc1 Ls2_go
    s_movk_i32 s54, 32
    s_cmp_eq_u32 s45, 44
    s_cselect_b32 s63, 1, 0
    s_cmp_lt_u32 s6, 6
    s_cselect_b32 s63, s63, 0
    s_cselect_b32 s46, s6, 0
Ls2_go:
    s_cmp_ge_u32 s46, 6
    s_cselect_b32 s55, 1, 0
    s_cselect_b32 s44, 6, 0
    s_sub_u32 s44, s46, s44
    s_cmp_eq_u32 s46, 5
    s_cselect_b32 s51, 1073741824, 0
    s_cselect_b32 s52, 0x1ffff, -1
    s_movk_i32 s53, 0x3ff
    s_cselect_b32 s53, 0x3fc, s53
    s_bfe_u32 s45, s54, 0x10004
    s_lshl1_add_u32 s45, s55, s45
    s_mul_i32 s45, s45, 11
    s_lshl1_add_u32 s45, s44, s45
    s_mul_i32 s48, s45, 34816
    s_add_u32 s48, s48, 8388608
    s_add_u32 s47, s48, 34816
    s_add_u32 s47, s47, s51
    s_mul_i32 s46, s55, 33
    s_add_u32 s46, s46, s54
    s_mul_i32 s49, s46, 33792
    s_add_u32 s49, s49, 5242880
    s_mul_i32 s56, s46, 6
    s_add_u32 s56, s56, s44
    s_lshl_b32 s56, s56, 7
    s_add_u32 s56, s56, 819200
    s_mul_i32 s45, s55, 11
    s_lshl1_add_u32 s45, s44, s45
    s_mul_i32 s45, s45, 2176
    s_add_u32 s45, s45, 720896
    s_lshl_b32 s46, s46, 10
    s_add_u32 s46, s46, 631680
    s_mul_i32 s54, s54, 45056
    s_lshl_b32 s44, s44, 13
    s_add_u32 s54, s54, s44
    s_mul_i32 s44, s55, 2097152
    s_add_u32 s54, s54, s44
    s_add_u32 s54, s54, 10485760
    s_add_u32 s55, s54, 4096
    s_add_u32 s55, s55, s51
    s_mov_b32 s44, 34
    s_mov_b32 s62, 2
    s_mov_b32 s59, 32
Ls_set:
    v_mov_b32 v2, s45
    v_mov_b32 v3, s46
    v_cmp_gt_u32 vcc, s44, v0
    v_mov_b32 v10, s56
    s_nop 0
    v_cndmask_b32 v2, v3, v2, vcc
    v_lshl_add_u32 v2, v0, 7, v2
    s_waitcnt vmcnt(1)
    s_mov_b64 exec, 1
    buffer_store_dword v8, v137, s[24:27], 0 offen sc1
    s_mov_b64 exec, -1
Lstage:
Lw53:
    ds_read_b32 v13, v15 offset:32
    s_waitcnt lgkmcnt(0)
    v_readfirstlane_b32 s44, v13
    s_cmp_ge_u32 s44, s59
    s_cbranch_scc1 Lwd54
    s_sub_u32 s92, s92, 1
    s_cbranch_scc1 Lwd54
    s_sleep 4
    s_branch Lw53
Lwd54:
    s_cmp_eq_u32 s63, 0
    s_cbranch_scc1 Lstage_next
    s_sub_u32 s59, s62, 1
Lw55:
    ds_read_b32 v13, v15 offset:36
    s_waitcnt lgkmcnt(0)
    v_readfirstlane_b32 s44, v13
    s_cmp_ge_u32 s44, s59
    s_cbranch_scc1 Lwd56
    s_sub_u32 s92, s92, 1
    s_cbranch_scc1 Lwd56
    s_sleep 4
    s_branch Lw55
Lwd56:
    s_mov_b64 exec, s[52:53]
Lg57:
    buffer_load_dword v160, v2, s[24:27], 0 offen sc1
    s_waitcnt vmcnt(0)
    v_cmpx_ne_u32 vcc, s32, v160
    s_cmp_eq_u64 exec, 0
    s_cbranch_scc1 Lgd58
    s_sub_u32 s92, s92, 1
    s_cbranch_scc1 Lgd58
    s_sleep 8
    s_branch Lg57
Lgd58:
    s_mov_b64 exec, -1
    s_cmp_eq_u32 s62, 2
    s_cbranch_scc1 Ls_nomid
    s_bitcmp1_b32 s50, 30
    s_cbranch_scc1 Ls_nomid
    v_lshlrev_b32 v3, 2, v0
    v_mov_b32 v156, 0
    v_mov_b32 v157, 0
    v_lshlrev_b32 v160, 31, v0
    s_mov_b32 exec_hi, 0
    buffer_load_dword v156, v3, s[24:27], s50 offen sc1
    s_mov_b32 exec_hi, -1
    v_or_b32 v160, 1.0, v160
    v_mov_b32 v159, 0
    v_mov_b32 v161, 0
    v_lshrrev_b32 v158, 16, v160
Ls_nomid:
    s_setprio 0
    buffer_load_dwordx4 v[24:27], v1, s[24:27], s49 offen offset:0
    buffer_load_dwordx4 v[16:19], v1, s[24:27], s48 offen offset:0
    buffer_load_dwordx4 v[20:23], v1, s[24:27], s47 offen offset:0
    buffer_load_dwordx4 v[36:39], v1, s[24:27], s49 offen offset:1024
    buffer_load_dwordx4 v[28:31], v1, s[24:27], s48 offen offset:1024
    buffer_load_dwordx4 v[32:35], v1, s[24:27], s47 offen offset:1024
    buffer_load_dwordx4 v[48:51], v1, s[24:27], s49 offen offset:2048
    buffer_load_dwordx4 v[40:43], v1, s[24:27], s48 offen offset:2048
    buffer_load_dwordx4 v[44:47], v1, s[24:27], s47 offen offset:2048
    buffer_load_dwordx4 v[60:63], v1, s[24:27], s49 offen offset:3072
    buffer_load_dwordx4 v[52:55], v1, s[24:27], s48 offen offset:3072
    buffer_load_dwordx4 v[56:59], v1, s[24:27], s47 offen offset:3072
    s_add_u32 s47, s47, 4096
    s_add_u32 s48, s48, 4096
    s_add_u32 s49, s49, 4096
    buffer_load_dwordx4 v[72:75], v1, s[24:27], s49 offen offset:0
    buffer_load_dwordx4 v[64:67], v1, s[24:27], s48 offen offset:0
    buffer_load_dwordx4 v[68:71], v1, s[24:27], s47 offen offset:0
    buffer_load_dwordx4 v[84:87], v1, s[24:27], s49 offen offset:1024
    buffer_load_dwordx4 v[76:79], v1, s[24:27], s48 offen offset:1024
    buffer_load_dwordx4 v[80:83], v1, s[24:27], s47 offen offset:1024
    buffer_load_dwordx4 v[96:99], v1, s[24:27], s49 offen offset:2048
    buffer_load_dwordx4 v[88:91], v1, s[24:27], s48 offen offset:2048
    buffer_load_dwordx4 v[92:95], v1, s[24:27], s47 offen offset:2048
    buffer_load_dwordx4 v[108:111], v1, s[24:27], s49 offen offset:3072
    buffer_load_dwordx4 v[100:103], v1, s[24:27], s48 offen offset:3072
    buffer_load_dwordx4 v[104:107], v1, s[24:27], s47 offen offset:3072
    s_add_u32 s47, s47, 4096
    s_add_u32 s48, s48, 4096
    s_add_u32 s49, s49, 4096
    buffer_load_dwordx4 v[120:123], v1, s[24:27], s49 offen offset:0
    buffer_load_dwordx4 v[112:115], v1, s[24:27], s48 offen offset:0
    buffer_load_dwordx4 v[116:119], v1, s[24:27], s47 offen offset:0
    s_waitcnt vmcnt(24)
    v_mfma_f32_32x32x16_bf16 v[124:139], v[16:19], v[24:27], 0
    v_mfma_f32_32x32x16_bf16 v[140:155], v[20:23], v[24:27], 0
    buffer_load_dwordx4 v[24:27], v1, s[24:27], s49 offen offset:1024
    buffer_load_dwordx4 v[16:19], v1, s[24:27], s48 offen offset:1024
    buffer_load_dwordx4 v[20:23], v1, s[24:27], s47 offen offset:1024
    s_waitcnt vmcnt(24)
    v_mfma_f32_32x32x16_bf16 v[124:139], v[28:31], v[36:39], v[124:139]
    v_mfma_f32_32x32x16_bf16 v[140:155], v[32:35], v[36:39], v[140:155]
    buffer_load_dwordx4 v[36:39], v1, s[24:27], s49 offen offset:2048
    buffer_load_dwordx4 v[28:31], v1, s[24:27], s48 offen offset:2048
    buffer_load_dwordx4 v[32:35], v1, s[24:27], s47 offen offset:2048
    s_waitcnt vmcnt(24)
    v_mfma_f32_32x32x16_bf16 v[124:139], v[40:43], v[48:51], v[124:139]
    v_mfma_f32_32x32x16_bf16 v[140:155], v[44:47], v[48:51], v[140:155]
    buffer_load_dwordx4 v[48:51], v1, s[24:27], s49 offen offset:3072
    buffer_load_dwordx4 v[40:43], v1, s[24:27], s48 offen offset:3072
    buffer_load_dwordx4 v[44:47], v1, s[24:27], s47 offen offset:3072
    s_waitcnt vmcnt(24)
    v_mfma_f32_32x32x16_bf16 v[124:139], v[52:55], v[60:63], v[124:139]
    v_mfma_f32_32x32x16_bf16 v[140:155], v[56:59], v[60:63], v[140:155]
    s_add_u32 s47, s47, 4096
    s_add_u32 s48, s48, 4096
    s_add_u32 s49, s49, 4096
    buffer_load_dwordx4 v[60:63], v1, s[24:27], s49 offen offset:0
    buffer_load_dwordx4 v[52:55], v1, s[24:27], s48 offen offset:0
    buffer_load_dwordx4 v[56:59], v1, s[24:27], s47 offen offset:0
    s_waitcnt vmcnt(24)
    v_mfma_f32_32x32x16_bf16 v[124:139], v[64:67], v[72:75], v[124:139]
    v_mfma_f32_32x32x16_bf16 v[140:155], v[68:71], v[72:75], v[140:155]
    buffer_load_dwordx4 v[72:75], v1, s[24:27], s49 offen offset:1024
    buffer_load_dwordx4 v[64:67], v1, s[24:27], s48 offen offset:1024
    buffer_load_dwordx4 v[68:71], v1, s[24:27], s47 offen offset:1024
    s_waitcnt vmcnt(24)
    v_mfma_f32_32x32x16_bf16 v[124:139], v[76:79], v[84:87], v[124:139]
    v_mfma_f32_32x32x16_bf16 v[140:155], v[80:83], v[84:87], v[140:155]
    buffer_load_dwordx4 v[84:87], v1, s[24:27], s49 offen offset:2048
    buffer_load_dwordx4 v[76:79], v1, s[24:27], s48 offen offset:2048
    buffer_load_dwordx4 v[80:83], v1, s[24:27], s47 offen offset:2048
    s_waitcnt vmcnt(24)
    v_mfma_f32_32x32x16_bf16 v[124:139], v[88:91], v[96:99], v[124:139]
    v_mfma_f32_32x32x16_bf16 v[140:155], v[92:95], v[96:99], v[140:155]
    buffer_load_dwordx4 v[96:99], v1, s[24:27], s49 offen offset:3072
    buffer_load_dwordx4 v[88:91], v1, s[24:27], s48 offen offset:3072
    buffer_load_dwordx4 v[92:95], v1, s[24:27], s47 offen offset:3072
    s_waitcnt vmcnt(24)
    v_mfma_f32_32x32x16_bf16 v[124:139], v[100:103], v[108:111], v[124:139]
    v_mfma_f32_32x32x16_bf16 v[140:155], v[104:107], v[108:111], v[140:155]
    s_add_u32 s47, s47, 4096
    s_add_u32 s48, s48, 4096
    s_add_u32 s49, s49, 4096
    buffer_load_dwordx4 v[108:111], v1, s[24:27], s49 offen offset:0
    buffer_load_dwordx4 v[100:103], v1, s[24:27], s48 offen offset:0
    buffer_load_dwordx4 v[104:107], v1, s[24:27], s47 offen offset:0
    s_waitcnt vmcnt(24)
    v_mfma_f32_32x32x16_bf16 v[124:139], v[112:115], v[120:123], v[124:139]
    v_mfma_f32_32x32x16_bf16 v[140:155], v[116:119], v[120:123], v[140:155]
    buffer_load_dwordx4 v[120:123], v1, s[24:27], s49 offen offset:1024
    buffer_load_dwordx4 v[112:115], v1, s[24:27], s48 offen offset:1024
    buffer_load_dwordx4 v[116:119], v1, s[24:27], s47 offen offset:1024
    s_waitcnt vmcnt(24)
    v_mfma_f32_32x32x16_bf16 v[124:139], v[16:19], v[24:27], v[124:139]
    v_mfma_f32_32x32x16_bf16 v[140:155], v[20:23], v[24:27], v[140:155]
    buffer_load_dwordx4 v[24:27], v1, s[24:27], s49 offen offset:2048
    buffer_load_dwordx4 v[16:19], v1, s[24:27], s48 offen offset:2048
    buffer_load_dwordx4 v[20:23], v1, s[24:27], s47 offen offset:2048
    s_waitcnt vmcnt(24)
    v_mfma_f32_32x32x16_bf16 v[124:139], v[28:31], v[36:39], v[124:139]
    v_mfma_f32_32x32x16_bf16 v[140:155], v[32:35], v[36:39], v[140:155]
    buffer_load_dwordx4 v[36:39], v1, s[24:27], s49 offen offset:3072
    buffer_load_dwordx4 v[28:31], v1, s[24:27], s48 offen offset:3072
    buffer_load_dwordx4 v[32:35], v1, s[24:27], s47 offen offset:3072
    s_cmp_eq_u32 s62, 2
    s_cbranch_scc1 Ls2_rest
    s_waitcnt vmcnt(24)
    v_mfma_f32_32x32x16_bf16 v[124:139], v[40:43], v[48:51], v[124:139]
    v_mfma_f32_32x32x16_bf16 v[140:155], v[44:47], v[48:51], v[140:155]
    s_waitcnt vmcnt(21)
    v_mfma_f32_32x32x16_bf16 v[124:139], v[52:55], v[60:63], v[124:139]
    v_mfma_f32_32x32x16_bf16 v[140:155], v[56:59], v[60:63], v[140:155]
    s_waitcnt vmcnt(18)
    v_mfma_f32_32x32x16_bf16 v[124:139], v[64:67], v[72:75], v[124:139]
    v_mfma_f32_32x32x16_bf16 v[140:155], v[68:71], v[72:75], v[140:155]
    s_waitcnt vmcnt(15)
    v_mfma_f32_32x32x16_bf16 v[124:139], v[76:79], v[84:87], v[124:139]
    v_mfma_f32_32x32x16_bf16 v[140:155], v[80:83], v[84:87], v[140:155]
    s_waitcnt vmcnt(12)
    v_mfma_f32_32x32x16_bf16 v[124:139], v[88:91], v[96:99], v[124:139]
    v_mfma_f32_32x32x16_bf16 v[140:155], v[92:95], v[96:99], v[140:155]
    s_waitcnt vmcnt(9)
    v_mfma_f32_32x32x16_bf16 v[124:139], v[100:103], v[108:111], v[124:139]
    v_mfma_f32_32x32x16_bf16 v[140:155], v[104:107], v[108:111], v[140:155]
    s_waitcnt vmcnt(6)
    v_mfma_f32_32x32x16_bf16 v[124:139], v[112:115], v[120:123], v[124:139]
    v_mfma_f32_32x32x16_bf16 v[140:155], v[116:119], v[120:123], v[140:155]
    s_waitcnt vmcnt(3)
    v_mfma_f32_32x32x16_bf16 v[124:139], v[16:19], v[24:27], v[124:139]
    v_mfma_f32_32x32x16_bf16 v[140:155], v[20:23], v[24:27], v[140:155]
    s_waitcnt vmcnt(0)
    v_mfma_f32_32x32x16_bf16 v[124:139], v[28:31], v[36:39], v[124:139]
    v_mfma_f32_32x32x16_bf16 v[140:155], v[32:35], v[36:39], v[140:155]
    s_setprio 3
    s_bitcmp1_b32 s50, 30
    s_cbranch_scc1 Ls1_nomid
    v_mfma_f32_32x32x8_bf16 v[124:139], v[156:157], v[158:159], v[124:139]
    v_mfma_f32_32x32x8_bf16 v[140:155], v[156:157], v[160:161], v[140:155]
Ls1_nomid:
    s_nop 7
    s_nop 7
    v_cvt_pk_bf16_f32 v16, v124, v125
    v_cvt_pk_bf16_f32 v17, v126, v127
    v_cvt_pk_bf16_f32 v18, v128, v129
    v_cvt_pk_bf16_f32 v19, v130, v131
    v_cvt_pk_bf16_f32 v20, v132, v133
    v_cvt_pk_bf16_f32 v21, v134, v135
    v_cvt_pk_bf16_f32 v22, v136, v137
    v_cvt_pk_bf16_f32 v23, v138, v139
    v_cvt_pk_bf16_f32 v24, v140, v141
    v_cvt_pk_bf16_f32 v25, v142, v143
    v_cvt_pk_bf16_f32 v26, v144, v145
    v_cvt_pk_bf16_f32 v27, v146, v147
    v_cvt_pk_bf16_f32 v28, v148, v149
    v_cvt_pk_bf16_f32 v29, v150, v151
    v_cvt_pk_bf16_f32 v30, v152, v153
    v_cvt_pk_bf16_f32 v31, v154, v155
    buffer_store_dwordx4 v[16:19], v1, s[24:27], s54 offen offset:0 sc1
    buffer_store_dwordx4 v[20:23], v1, s[24:27], s54 offen offset:1024 sc1
    buffer_store_dwordx4 v[24:27], v1, s[24:27], s55 offen offset:0 sc1
    buffer_store_dwordx4 v[28:31], v1, s[24:27], s55 offen offset:1024 sc1
    s_branch Lstage_flag
Ls2_rest:
    s_waitcnt vmcnt(24)
    v_mfma_f32_32x32x16_bf16 v[124:139], v[40:43], v[48:51], v[124:139]
    v_mfma_f32_32x32x16_bf16 v[140:155], v[44:47], v[48:51], v[140:155]
    s_add_u32 s47, s47, 4096
    s_add_u32 s48, s48, 4096
    s_add_u32 s49, s49, 4096
    buffer_load_dwordx4 v[48:51], v1, s[24:27], s49 offen offset:0
    buffer_load_dwordx4 v[40:43], v1, s[24:27], s48 offen offset:0
    buffer_load_dwordx4 v[44:47], v1, s[24:27], s47 offen offset:0
    s_waitcnt vmcnt(24)
    v_mfma_f32_32x32x16_bf16 v[124:139], v[52:55], v[60:63], v[124:139]
    v_mfma_f32_32x32x16_bf16 v[140:155], v[56:59], v[60:63], v[140:155]
    buffer_load_dwordx4 v[60:63], v1, s[24:27], s49 offen offset:1024
    buffer_load_dwordx4 v[52:55], v1, s[24:27], s48 offen offset:1024
    buffer_load_dwordx4 v[56:59], v1, s[24:27], s47 offen offset:1024
    s_waitcnt vmcnt(24)
    v_mfma_f32_32x32x16_bf16 v[124:139], v[64:67], v[72:75], v[124:139]
    v_mfma_f32_32x32x16_bf16 v[140:155], v[68:71], v[72:75], v[140:155]
    buffer_load_dwordx4 v[72:75], v1, s[24:27], s49 offen offset:2048
    buffer_load_dwordx4 v[64:67], v1, s[24:27], s48 offen offset:2048
    buffer_load_dwordx4 v[68:71], v1, s[24:27], s47 offen offset:2048
    s_waitcnt vmcnt(24)
    v_mfma_f32_32x32x16_bf16 v[124:139], v[76:79], v[84:87], v[124:139]
    v_mfma_f32_32x32x16_bf16 v[140:155], v[80:83], v[84:87], v[140:155]
    buffer_load_dwordx4 v[84:87], v1, s[24:27], s49 offen offset:3072
    buffer_load_dwordx4 v[76:79], v1, s[24:27], s48 offen offset:3072
    buffer_load_dwordx4 v[80:83], v1, s[24:27], s47 offen offset:3072
    s_waitcnt vmcnt(24)
    v_mfma_f32_32x32x16_bf16 v[124:139], v[88:91], v[96:99], v[124:139]
    v_mfma_f32_32x32x16_bf16 v[140:155], v[92:95], v[96:99], v[140:155]
    s_add_u32 s47, s47, 4096
    s_add_u32 s48, s48, 4096
    s_add_u32 s49, s49, 4096
    buffer_load_dwordx4 v[96:99], v1, s[24:27], s49 offen offset:0
    buffer_load_dwordx4 v[88:91], v1, s[24:27], s48 offen offset:0
    buffer_load_dwordx4 v[92:95], v1, s[24:27], s47 offen offset:0
    s_waitcnt vmcnt(24)
    v_mfma_f32_32x32x16_bf16 v[124:139], v[100:103], v[108:111], v[124:139]
    v_mfma_f32_32x32x16_bf16 v[140:155], v[104:107], v[108:111], v[140:155]
    buffer_load_dwordx4 v[108:111], v1, s[24:27], s49 offen offset:1024
    buffer_load_dwordx4 v[100:103], v1, s[24:27], s48 offen offset:1024
    buffer_load_dwordx4 v[104:107], v1, s[24:27], s47 offen offset:1024
    s_waitcnt vmcnt(24)
    v_mfma_f32_32x32x16_bf16 v[124:139], v[112:115], v[120:123], v[124:139]
    v_mfma_f32_32x32x16_bf16 v[140:155], v[116:119], v[120:123], v[140:155]
    buffer_load_dwordx4 v[120:123], v1, s[24:27], s49 offen offset:2048
    buffer_load_dwordx4 v[112:115], v1, s[24:27], s48 offen offset:2048
    buffer_load_dwordx4 v[116:119], v1, s[24:27], s47 offen offset:2048
    s_waitcnt vmcnt(24)
    v_mfma_f32_32x32x16_bf16 v[124:139], v[16:19], v[24:27], v[124:139]
    v_mfma_f32_32x32x16_bf16 v[140:155], v[20:23], v[24:27], v[140:155]
    buffer_load_dwordx4 v[24:27], v1, s[24:27], s49 offen offset:3072
    buffer_load_dwordx4 v[16:19], v1, s[24:27], s48 offen offset:3072
    buffer_load_dwordx4 v[20:23], v1, s[24:27], s47 offen offset:3072
    s_waitcnt vmcnt(24)
    v_mfma_f32_32x32x16_bf16 v[124:139], v[28:31], v[36:39], v[124:139]
    v_mfma_f32_32x32x16_bf16 v[140:155], v[32:35], v[36:39], v[140:155]
    s_add_u32 s47, s47, 4096
    s_add_u32 s48, s48, 4096
    s_add_u32 s49, s49, 4096
    buffer_load_dwordx4 v[36:39], v1, s[24:27], s49 offen offset:0
    buffer_load_dwordx4 v[28:31], v1, s[24:27], s48 offen offset:0
    buffer_load_dwordx4 v[32:35], v1, s[24:27], s47 offen offset:0
    s_waitcnt vmcnt(24)
    v_mfma_f32_32x32x16_bf16 v[124:139], v[40:43], v[48:51], v[124:139]
    v_mfma_f32_32x32x16_bf16 v[140:155], v[44:47], v[48:51], v[140:155]
    buffer_load_dwordx4 v[48:51], v1, s[24:27], s49 offen offset:1024
    buffer_load_dwordx4 v[40:43], v1, s[24:27], s48 offen offset:1024
    buffer_load_dwordx4 v[44:47], v1, s[24:27], s47 offen offset:1024
    s_waitcnt vmcnt(24)
    v_mfma_f32_32x32x16_bf16 v[124:139], v[52:55], v[60:63], v[124:139]
    v_mfma_f32_32x32x16_bf16 v[140:155], v[56:59], v[60:63], v[140:155]
    buffer_load_dwordx4 v[60:63], v1, s[24:27], s49 offen offset:2048
    buffer_load_dwordx4 v[52:55], v1, s[24:27], s48 offen offset:2048
    buffer_load_dwordx4 v[56:59], v1, s[24:27], s47 offen offset:2048
    s_waitcnt vmcnt(24)
    v_mfma_f32_32x32x16_bf16 v[124:139], v[64:67], v[72:75], v[124:139]
    v_mfma_f32_32x32x16_bf16 v[140:155], v[68:71], v[72:75], v[140:155]
    buffer_load_dwordx4 v[72:75], v1, s[24:27], s49 offen offset:3072
    buffer_load_dwordx4 v[64:67], v1, s[24:27], s48 offen offset:3072
    buffer_load_dwordx4 v[68:71], v1, s[24:27], s47 offen offset:3072
    s_waitcnt vmcnt(24)
    v_mfma_f32_32x32x16_bf16 v[124:139], v[76:79], v[84:87], v[124:139]
    v_mfma_f32_32x32x16_bf16 v[140:155], v[80:83], v[84:87], v[140:155]
    s_add_u32 s47, s47, 4096
    s_add_u32 s48, s48, 4096
    s_add_u32 s49, s49, 4096
    buffer_load_dwordx4 v[84:87], v1, s[24:27], s49 offen offset:0
    buffer_load_dwordx4 v[76:79], v1, s[24:27], s48 offen offset:0
    buffer_load_dwordx4 v[80:83], v1, s[24:27], s47 offen offset:0
    s_waitcnt vmcnt(24)
    v_mfma_f32_32x32x16_bf16 v[124:139], v[88:91], v[96:99], v[124:139]
    v_mfma_f32_32x32x16_bf16 v[140:155], v[92:95], v[96:99], v[140:155]
    s_waitcnt vmcnt(21)
    v_mfma_f32_32x32x16_bf16 v[124:139], v[100:103], v[108:111], v[124:139]
    v_mfma_f32_32x32x16_bf16 v[140:155], v[104:107], v[108:111], v[140:155]
    s_waitcnt vmcnt(18)
    v_mfma_f32_32x32x16_bf16 v[124:139], v[112:115], v[120:123], v[124:139]
    v_mfma_f32_32x32x16_bf16 v[140:155], v[116:119], v[120:123], v[140:155]
    s_waitcnt vmcnt(15)
    v_mfma_f32_32x32x16_bf16 v[124:139], v[16:19], v[24:27], v[124:139]
    v_mfma_f32_32x32x16_bf16 v[140:155], v[20:23], v[24:27], v[140:155]
    s_waitcnt vmcnt(12)
    v_mfma_f32_32x32x16_bf16 v[124:139], v[28:31], v[36:39], v[124:139]
    v_mfma_f32_32x32x16_bf16 v[140:155], v[32:35], v[36:39], v[140:155]
    s_waitcnt vmcnt(9)
    v_mfma_f32_32x32x16_bf16 v[124:139], v[40:43], v[48:51], v[124:139]
    v_mfma_f32_32x32x16_bf16 v[140:155], v[44:47], v[48:51], v[140:155]
    s_waitcnt vmcnt(6)
    v_mfma_f32_32x32x16_bf16 v[124:139], v[52:55], v[60:63], v[124:139]
    v_mfma_f32_32x32x16_bf16 v[140:155], v[56:59], v[60:63], v[140:155]
    s_waitcnt vmcnt(3)
    v_mfma_f32_32x32x16_bf16 v[124:139], v[64:67], v[72:75], v[124:139]
    v_mfma_f32_32x32x16_bf16 v[140:155], v[68:71], v[72:75], v[140:155]
    s_waitcnt vmcnt(0)
    v_mfma_f32_32x32x16_bf16 v[124:139], v[76:79], v[84:87], v[124:139]
    v_mfma_f32_32x32x16_bf16 v[140:155], v[80:83], v[84:87], v[140:155]
    s_setprio 3
    s_nop 7
    s_nop 7
    buffer_store_dwordx4 v[124:127], v1, s[24:27], s54 offen offset:0 sc1
    buffer_store_dwordx4 v[128:131], v1, s[24:27], s54 offen offset:1024 sc1
    buffer_store_dwordx4 v[132:135], v1, s[24:27], s54 offen offset:2048 sc1
    buffer_store_dwordx4 v[136:139], v1, s[24:27], s54 offen offset:3072 sc1
    buffer_store_dwordx4 v[140:143], v1, s[24:27], s55 offen offset:0 sc1
    buffer_store_dwordx4 v[144:147], v1, s[24:27], s55 offen offset:1024 sc1
    buffer_store_dwordx4 v[148:151], v1, s[24:27], s55 offen offset:2048 sc1
    buffer_store_dwordx4 v[152:155], v1, s[24:27], s55 offen offset:3072 sc1
Lstage_flag:
    s_waitcnt vmcnt(0)
    s_mov_b64 exec, 1
    buffer_store_dword v8, v10, s[24:27], 0 offen sc1
    s_mov_b64 exec, -1
Lstage_next:
    ds_write_b32 v15, v14 offset:36
Lwo:
    s_mul_i32 s45, s5, 160
    s_movk_i32 s46, 1280
    v_and_b32 v9, 15, v0
    v_lshrrev_b32 v12, 4, v0
    s_lshl_b32 s58, s93, 4
    v_add_u32 v10, s58, v9
    v_lshl_add_u32 v107, v10, 2, v15
    s_lshl_b32 s57, s4, 6
    v_add_u32 v11, s57, v10
    v_mul_u32_u24 v13, 40, v12
    v_mad_u32_u24 v6, v11, s46, v13
    v_add_u32 v6, s45, v6
    v_lshlrev_b32 v5, 16, v12
    v_lshl_add_u32 v4, v11, 3, v5
    v_lshlrev_b32 v5, 15, v12
    v_lshl_add_u32 v5, v11, 4, v5
    v_add_u32 v4, 18874368, v4
    v_add_u32 v5, 16777216, v5
    s_lshl_b32 s71, s5, 18
    s_add_u32 s64, s71, 0x40000
    s_and_b32 s64, s64, 0x1fffff
    s_add_u32 s65, s64, 0x40000
    s_and_b32 s65, s65, 0x1fffff
    s_add_u32 s66, s65, 0x40000
    s_and_b32 s66, s66, 0x1fffff
    s_add_u32 s67, s66, 0x40000
    s_and_b32 s67, s67, 0x1fffff
    s_add_u32 s68, s67, 0x40000
    s_and_b32 s68, s68, 0x1fffff
    s_add_u32 s69, s68, 0x40000
    s_and_b32 s69, s69, 0x1fffff
    s_add_u32 s70, s69, 0x40000
    s_and_b32 s70, s70, 0x1fffff
    s_cmp_lt_u32 s5, 4
    s_cselect_b32 s72, 0x40000, 0
    s_add_u32 s73, s72, 16384
    s_xor_b32 s74, s72, 0x40000
    s_xor_b32 s75, s73, 0x40000
    s_cmp_lt_u32 s4, 16
    s_cselect_b32 s50, 0, 1
    s_cbranch_scc1 Lw_lo
    v_sub_u32 v11, 2048, v11
Lw_lo:
    s_movk_i32 s44, 1024
    v_cmp_ne_u32 s[60:61], s44, v11
    v_and_b32 v10, 1, v11
    v_lshrrev_b32 v13, 6, v11
    v_lshl_add_u32 v10, v10, 4, v13
    v_lshrrev_b32 v13, 10, v11
    v_lshl_add_u32 v10, v13, 4, v10
    v_mul_u32_u24 v10, 45056, v10
    v_bfe_u32 v11, v11, 1, 5
    v_lshl_add_u32 v10, v11, 4, v10
    s_mul_i32 s59, s5, 20
    s_sub_u32 s56, 155, s59
    s_cmp_ge_u32 s5, 4
    s_cselect_b32 s59, s56, s59
    s_cselect_b32 s51, 1, 0
    s_movk_i32 s56, 2560
    s_cselect_b32 s56, -2560, s56
    s_lshl_b32 s57, s59, 9
    s_cmp_eq_u32 s50, s51
    s_cselect_b32 s33, 0xbf800000, 0x3f800000
    v_mul_i32_i24 v11, s56, v12
    v_add3_u32 v106, v10, v11, s57
    s_cmp_eq_u32 s5, 4
    s_cselect_b32 s62, 0xffff0000, -1
    s_and_b32 s62, s62, s60
    s_cmp_eq_u32 s62, -1
    s_cbranch_scc1 Lw_noz
    v_mov_b32 v136, 0
    v_mov_b32 v137, 0
    v_mov_b32 v138, 0
    v_mov_b32 v139, 0
    v_mov_b32 v140, 0
    v_mov_b32 v141, 0
    v_mov_b32 v142, 0
    v_mov_b32 v143, 0
    v_mov_b32 v144, 0
    v_mov_b32 v145, 0
    v_mov_b32 v146, 0
    v_mov_b32 v147, 0
    v_mov_b32 v148, 0
    v_mov_b32 v149, 0
    v_mov_b32 v150, 0
    v_mov_b32 v151, 0
    v_mov_b32 v152, 0
    v_mov_b32 v153, 0
    v_mov_b32 v154, 0
    v_mov_b32 v155, 0
    v_mov_b32 v156, 0
    v_mov_b32 v157, 0
    v_mov_b32 v158, 0
    v_mov_b32 v159, 0
Lw_noz:
    v_mov_b32 v16, 0
    v_mov_b32 v17, 0
    v_mov_b32 v18, 0
    v_mov_b32 v19, 0
    v_mov_b32 v20, 0
    v_mov_b32 v21, 0
    v_mov_b32 v22, 0
    v_mov_b32 v23, 0
    v_mov_b32 v24, 0
    v_mov_b32 v25, 0
    v_mov_b32 v26, 0
    v_mov_b32 v27, 0
    v_mov_b32 v28, 0
    v_mov_b32 v29, 0
    v_mov_b32 v30, 0
    v_mov_b32 v31, 0
    v_mov_b32 v32, 0
    v_mov_b32 v33, 0
    v_mov_b32 v34, 0
    v_mov_b32 v35, 0
    s_mov_b32 s58, 0
    s_mov_b32 s63, 0
    s_mov_b32 s35, 5
    s_mov_b32 s34, 67
    s_cmp_lg_u32 s93, 3
    s_cbranch_scc1 Lh_loop
    s_mul_i32 s56, s51, 15
    s_sub_u32 s56, s59, s56
    s_add_u32 s57, s56, 19
    s_add_u32 s57, s57, s51
    s_lshr_b32 s56, s56, 3
    s_lshr_b32 s57, s57, 3
    s_sub_u32 s44, 31, s4
    s_cmp_ge_u32 s4, 16
    s_cselect_b32 s44, s44, s4
    s_cselect_b32 s45, 1, 0
    s_add_u32 s45, s45, s44
    s_cmp_eq_u32 s45, 16
    s_cselect_b32 s45, 32, s45
    s_add_u32 s46, s44, 16
    v_lshrrev_b32 v10, 2, v0
    v_and_b32 v11, 3, v0
    v_add_u32 v11, s56, v11
    v_min_u32 v11, s57, v11
    v_cmp_le_u32 s[56:57], 3, v10
    v_subrev_u32 v12, 3, v10
    v_mov_b32 v9, s46
    v_cndmask_b32 v10, v10, v12, s[56:57]
    v_mov_b32 v12, s44
    v_cmp_eq_u32 vcc, 1, v10
    s_mov_b32 s35, 0
    s_mov_b32 s63, -1
    v_cndmask_b32 v12, v12, v9, vcc
    v_mov_b32 v9, s45
    v_cmp_eq_u32 vcc, 2, v10
    s_mov_b32 s34, 20
    s_mov_b32 s52, 8
    v_cndmask_b32 v12, v12, v9, vcc
    v_cmp_gt_u32 vcc, 10, v11
    v_cmp_gt_u32 s[44:45], 32, v12
    s_and_b64 vcc, vcc, s[56:57]
    s_and_b64 vcc, vcc, s[44:45]
    v_add_u32 v9, 33, v12
    v_cndmask_b32 v12, v12, v9, vcc
    v_lshrrev_b32 v11, 1, v11
    v_mad_u32_u24 v12, v12, 6, v11
    s_lshl_b32 s45, s4, 3
    s_add_u32 s45, s45, 744
    v_cmp_le_u32 vcc, 24, v0
    v_add_u32 v9, s45, v0
    s_mov_b32 s46, 819200
    v_cndmask_b32 v12, v12, v9, vcc
    s_mul_i32 s45, s5, 20
    s_add_u32 s45, s45, 992
    s_mov_b32 exec_lo, 0
    v_add_u32 v12, s45, v0
    s_mov_b32 exec_lo, -1
    s_mov_b32 s55, 0xfffff
    v_mov_b32 v162, 1
    v_mov_b32 v163, 0
    s_getreg_b32 s44, hwreg(HW_REG_XCC_ID, 0, 3)
    s_mov_b32 exec_lo, 0xff000000
    s_mov_b32 exec_hi, 0
    v_mov_b32 v162, 8
    v_mov_b32 v163, s44
    s_mov_b64 exec, -1
    s_mov_b32 s49, 0
    s_mul_i32 s54, s5, 102400
    s_add_u32 s54, s54, 14680064
    s_mov_b32 s53, 0
    v_lshlrev_b32 v12, 7, v12
    v_add_u32 v161, 96, v15
Lh_loop:
    s_cmp_lg_u32 s93, 3
    s_cbranch_scc1 Lh_nofy
    ds_read_b32 v110, v161
    s_waitcnt lgkmcnt(0)
    v_readfirstlane_b32 s44, v110
    s_cmp_ge_u32 s44, s52
    s_cselect_b32 s44, 4, 0
    s_or_b32 s58, s58, s44
    s_andn2_b32 s44, s34, s58
    s_cbranch_scc0 Lh_done
    s_or_b32 s44, s63, s55
    s_cbranch_scc0 Lh_nofy
    s_mov_b32 exec_lo, s63
    s_mov_b32 exec_hi, s55
    buffer_load_dword v108, v12, s[24:27], s46 offen sc1
    s_waitcnt vmcnt(0)
    v_xor_b32 v108, s32, v108
    v_cmp_le_u32 vcc, v162, v108
    v_cmp_ne_u32 s[56:57], v163, v108
    s_mov_b64 exec, -1
    s_mov_b32 s63, vcc_lo
    s_andn2_b32 s44, s56, s63
    s_or_b32 s49, s49, s44
    s_and_b32 s55, vcc_hi, -1
    s_cselect_b32 s44, 0, 16
    s_or_b32 s58, s58, s44
    s_lshr_b32 s44, s63, 24
    s_cselect_b32 s44, 0, 8
    s_or_b32 s58, s58, s44
    s_lshl_b32 s44, s63, 8
    s_cbranch_scc1 Lh_nofy
    ds_write_b32 v15, v14 offset:48
    s_bitcmp1_b32 s58, 5
    s_cbranch_scc1 Lh_nofy
    s_waitcnt lgkmcnt(0)
    s_wakeup
Lh_nofy:
    ds_read_b96 v[108:110], v15 offset:48
    s_waitcnt lgkmcnt(0)
    v_readfirstlane_b32 s48, v110
    v_readfirstlane_b32 s44, v108
    v_readfirstlane_b32 s45, v109
    s_cmp_ge_u32 s48, 4
    s_cselect_b32 s47, 64, 0
    s_or_b32 s58, s58, s47
    s_or_b32 s58, s58, s45
    s_lshl_b32 s44, s44, 5
    s_andn2_b32 s44, s44, s58
    s_cbranch_scc0 Lh_noy
    ds_read_b32 v107, v107 offset:256
    s_mov_b32 s44, 10485760
    s_mov_b32 s47, 12582912
    buffer_load_dwordx4 v[112:115], v106, s[24:27], s44 offen offset:0
    buffer_load_dwordx4 v[116:119], v106, s[24:27], s44 offen offset:512
    buffer_load_dwordx4 v[120:123], v106, s[24:27], s44 offen offset:1024
    buffer_load_dwordx4 v[124:127], v106, s[24:27], s44 offen offset:1536
    buffer_load_dwordx4 v[128:131], v106, s[24:27], s44 offen offset:2048
    s_cmp_lt_u32 s5, 4
    s_cbranch_scc1 Lh_y5
    buffer_load_dwordx4 v[132:135], v106, s[24:27], s44 offen offset:2560
    s_mov_b32 exec_lo, s62
    s_mov_b32 exec_hi, s61
    buffer_load_dwordx4 v[156:159], v106, s[24:27], s47 offen offset:2560
Lh_y5:
    s_mov_b64 exec, s[60:61]
    buffer_load_dwordx4 v[136:139], v106, s[24:27], s47 offen offset:0
    buffer_load_dwordx4 v[140:143], v106, s[24:27], s47 offen offset:512
    buffer_load_dwordx4 v[144:147], v106, s[24:27], s47 offen offset:1024
    buffer_load_dwordx4 v[148:151], v106, s[24:27], s47 offen offset:1536
    buffer_load_dwordx4 v[152:155], v106, s[24:27], s47 offen offset:2048
    s_mov_b64 exec, -1
    s_bitset1_b32 s58, 5
    s_waitcnt lgkmcnt(0)
Lh_noy:
    s_andn2_b32 s44, s34, s58
    s_cbranch_scc0 Lh_done
    s_and_b32 s44, s58, 34
    s_cmp_eq_u32 s44, 32
    s_cbranch_scc1 Lh_yadd
    s_sub_u32 s92, s92, 1
    s_cbranch_scc1 Lh_done
    s_cmp_lg_u32 s48, 0
    s_cbranch_scc1 Lh_short
    s_sleep 16
Lh_short:
    s_sleep 1
    s_branch Lh_loop
Lh_yadd:
    s_bitset1_b32 s58, 1
    v_sub_f32 v107, 1.0, v107
    v_mul_f32 v10, s33, v107
    s_waitcnt vmcnt(0)
    s_cmp_ge_u32 s5, 4
    s_cbranch_scc1 Ly_mir
    v_fmac_f32 v16, v107, v112
    v_fmac_f32 v17, v107, v113
    v_fmac_f32 v18, v107, v114
    v_fmac_f32 v19, v107, v115
    v_fmac_f32 v20, v107, v116
    v_fmac_f32 v21, v107, v117
    v_fmac_f32 v22, v107, v118
    v_fmac_f32 v23, v107, v119
    v_fmac_f32 v24, v107, v120
    v_fmac_f32 v25, v107, v121
    v_fmac_f32 v26, v107, v122
    v_fmac_f32 v27, v107, v123
    v_fmac_f32 v28, v107, v124
    v_fmac_f32 v29, v107, v125
    v_fmac_f32 v30, v107, v126
    v_fmac_f32 v31, v107, v127
    v_fmac_f32 v32, v107, v128
    v_fmac_f32 v33, v107, v129
    v_fmac_f32 v34, v107, v130
    v_fmac_f32 v35, v107, v131
    v_fmac_f32 v16, v10, v136
    v_fmac_f32 v17, v10, v137
    v_fmac_f32 v18, v10, v138
    v_fmac_f32 v19, v10, v139
    v_fmac_f32 v20, v10, v140
    v_fmac_f32 v21, v10, v141
    v_fmac_f32 v22, v10, v142
    v_fmac_f32 v23, v10, v143
    v_fmac_f32 v24, v10, v144
    v_fmac_f32 v25, v10, v145
    v_fmac_f32 v26, v10, v146
    v_fmac_f32 v27, v10, v147
    v_fmac_f32 v28, v10, v148
    v_fmac_f32 v29, v10, v149
    v_fmac_f32 v30, v10, v150
    v_fmac_f32 v31, v10, v151
    v_fmac_f32 v32, v10, v152
    v_fmac_f32 v33, v10, v153
    v_fmac_f32 v34, v10, v154
    v_fmac_f32 v35, v10, v155
    s_branch Lh_loop
Ly_mir:
    v_fmac_f32 v16, v107, v132
    v_fmac_f32 v17, v107, v131
    v_fmac_f32 v18, v107, v130
    v_fmac_f32 v19, v107, v129
    v_fmac_f32 v20, v107, v128
    v_fmac_f32 v21, v107, v127
    v_fmac_f32 v22, v107, v126
    v_fmac_f32 v23, v107, v125
    v_fmac_f32 v24, v107, v124
    v_fmac_f32 v25, v107, v123
    v_fmac_f32 v26, v107, v122
    v_fmac_f32 v27, v107, v121
    v_fmac_f32 v28, v107, v120
    v_fmac_f32 v29, v107, v119
    v_fmac_f32 v30, v107, v118
    v_fmac_f32 v31, v107, v117
    v_fmac_f32 v32, v107, v116
    v_fmac_f32 v33, v107, v115
    v_fmac_f32 v34, v107, v114
    v_fmac_f32 v35, v107, v113
    v_fmac_f32 v16, v10, v156
    v_fmac_f32 v17, v10, v155
    v_fmac_f32 v18, v10, v154
    v_fmac_f32 v19, v10, v153
    v_fmac_f32 v20, v10, v152
    v_fmac_f32 v21, v10, v151
    v_fmac_f32 v22, v10, v150
    v_fmac_f32 v23, v10, v149
    v_fmac_f32 v24, v10, v148
    v_fmac_f32 v25, v10, v147
    v_fmac_f32 v26, v10, v146
    v_fmac_f32 v27, v10, v145
    v_fmac_f32 v28, v10, v144
    v_fmac_f32 v29, v10, v143
    v_fmac_f32 v30, v10, v142
    v_fmac_f32 v31, v10, v141
    v_fmac_f32 v32, v10, v140
    v_fmac_f32 v33, v10, v139
    v_fmac_f32 v34, v10, v138
    v_fmac_f32 v35, v10, v137
    s_branch Lh_loop
Lh_done:
    s_add_u32 s35, s35, 1
    s_cmp_ge_u32 s35, 6
    s_cbranch_scc1 Lk_early
    s_cmp_eq_u32 s35, 5
    s_cbranch_scc1 Lh_go
    s_lshl_b32 s47, s35, 2
    s_lshr_b32 s47, 227440, s47
    s_and_b32 s47, s47, 15
Lh_cv:
    s_mov_b32 m0, s53
    s_add_u32 s53, s53, 4096
    buffer_load_dwordx4 v1, s[24:27], s54 offen offset:0 lds
    buffer_load_dwordx4 v1, s[24:27], s54 offen offset:1024 lds
    buffer_load_dwordx4 v1, s[24:27], s54 offen offset:2048 lds
    buffer_load_dwordx4 v1, s[24:27], s54 offen offset:3072 lds
    s_add_u32 s54, s54, 4096
    s_sub_u32 s47, s47, 1
    s_cmp_lg_u32 s47, 0
    s_cbranch_scc1 Lh_cv
    s_bitset0_b32 s58, 2
    v_add_u32 v161, 4, v161
    s_cmp_lt_u32 s35, 4
    s_cbranch_scc1 Lh_loop
    s_mov_b32 s34, 8
    s_branch Lh_loop
Lh_go:
    s_lshr_b32 s44, s63, 24
    s_or_b32 s44, s44, s49
    s_cselect_b32 s44, 0, 1
    v_mov_b32 v160, s44
    ds_write_b32 v15, v160 offset:60
    s_waitcnt vmcnt(0)
    ds_write_b32 v15, v14 offset:52
    s_mov_b32 s34, 67
    s_waitcnt lgkmcnt(0)
    s_wakeup
    s_branch Lh_loop
Lk_early:
    s_setprio 0
    s_mov_b32 s49, 1
    v_mov_b32 v10, v1
    v_add_u32 v162, 131072, v5
    v_add_u32 v163, 32768, v4
Lk_bulk:
    buffer_load_dwordx4 v[36:39], v5, s[24:27], s64 offen sc1
    buffer_load_dwordx4 v[40:43], v5, s[24:27], s65 offen sc1
    buffer_load_dwordx4 v[44:47], v5, s[24:27], s66 offen sc1
    buffer_load_dwordx4 v[48:51], v5, s[24:27], s67 offen sc1
    buffer_load_dwordx4 v[52:55], v5, s[24:27], s68 offen sc1
    buffer_load_dwordx4 v[56:59], v5, s[24:27], s69 offen sc1
    buffer_load_dwordx4 v[60:63], v5, s[24:27], s70 offen sc1
    buffer_load_dwordx4 v[64:67], v5, s[24:27], s71 offen sc1
    buffer_load_dwordx2 v[68:69], v4, s[24:27], s72 offen sc1
    buffer_load_dwordx2 v[70:71], v4, s[24:27], s73 offen sc1
    buffer_load_dwordx2 v[72:73], v4, s[24:27], s74 offen sc1
    buffer_load_dwordx2 v[74:75], v4, s[24:27], s75 offen sc1
Lk_pass:
    s_movk_i32 s50, 0x3ff
    ds_read_b128 v[76:79], v10 offset:0
    ds_read_b128 v[80:83], v10 offset:1024
    ds_read_b128 v[84:87], v10 offset:2048
    ds_read_b128 v[88:91], v10 offset:3072
    ds_read_b128 v[92:95], v10 offset:4096
    s_waitcnt vmcnt(11)
    v_max3_u32 v122, v36, v37, v38
    v_max_u32 v122, v122, v39
    v_cmp_eq_u32 vcc, -1, v122
Lk_b0:
    s_cbranch_vccnz Lk_n0
    s_waitcnt lgkmcnt(2)
    v_mfma_f32_16x16x32_bf16 v[16:19], v[76:79], v[36:39], v[16:19]
    ds_read_b128 v[124:127], v10 offset:5120
    ds_read_b128 v[128:131], v10 offset:6144
    ds_read_b128 v[132:135], v10 offset:7168
    v_mfma_f32_16x16x32_bf16 v[20:23], v[80:83], v[36:39], v[20:23]
    ds_read_b128 v[136:139], v10 offset:8192
    ds_read_b128 v[140:143], v10 offset:9216
    s_bitset0_b32 s50, 0
    v_mfma_f32_16x16x32_bf16 v[24:27], v[84:87], v[36:39], v[24:27]
    s_waitcnt vmcnt(10)
    v_max3_u32 v122, v40, v41, v42
    s_waitcnt lgkmcnt(5)
    v_mfma_f32_16x16x32_bf16 v[28:31], v[88:91], v[36:39], v[28:31]
    v_max_u32 v122, v122, v43
    v_cmp_eq_u32 vcc, -1, v122
    v_mfma_f32_16x16x32_bf16 v[32:35], v[92:95], v[36:39], v[32:35]
    s_bitcmp0_b32 s50, 1
    s_cbranch_scc1 Lk_t2
Lk_b1:
    s_cbranch_vccnz Lk_n1
    s_waitcnt lgkmcnt(2)
    v_mfma_f32_16x16x32_bf16 v[16:19], v[124:127], v[40:43], v[16:19]
    ds_read_b128 v[76:79], v10 offset:10240
    ds_read_b128 v[80:83], v10 offset:11264
    ds_read_b128 v[84:87], v10 offset:12288
    v_mfma_f32_16x16x32_bf16 v[20:23], v[128:131], v[40:43], v[20:23]
    ds_read_b128 v[88:91], v10 offset:13312
    ds_read_b128 v[92:95], v10 offset:14336
    s_bitset0_b32 s50, 1
    v_mfma_f32_16x16x32_bf16 v[24:27], v[132:135], v[40:43], v[24:27]
    s_waitcnt vmcnt(9)
    v_max3_u32 v122, v44, v45, v46
    s_waitcnt lgkmcnt(5)
    v_mfma_f32_16x16x32_bf16 v[28:31], v[136:139], v[40:43], v[28:31]
    v_max_u32 v122, v122, v47
    v_cmp_eq_u32 vcc, -1, v122
    v_mfma_f32_16x16x32_bf16 v[32:35], v[140:143], v[40:43], v[32:35]
    s_bitcmp0_b32 s50, 2
    s_cbranch_scc1 Lk_t3
Lk_b2:
    s_cbranch_vccnz Lk_n2
    s_waitcnt lgkmcnt(2)
    v_mfma_f32_16x16x32_bf16 v[16:19], v[76:79], v[44:47], v[16:19]
    ds_read_b128 v[124:127], v10 offset:15360
    ds_read_b128 v[128:131], v10 offset:16384
    ds_read_b128 v[132:135], v10 offset:17408
    v_mfma_f32_16x16x32_bf16 v[20:23], v[80:83], v[44:47], v[20:23]
    ds_read_b128 v[136:139], v10 offset:18432
    ds_read_b128 v[140:143], v10 offset:19456
    s_bitset0_b32 s50, 2
    v_mfma_f32_16x16x32_bf16 v[24:27], v[84:87], v[44:47], v[24:27]
    s_waitcnt vmcnt(8)
    v_max3_u32 v122, v48, v49, v50
    s_waitcnt lgkmcnt(5)
    v_mfma_f32_16x16x32_bf16 v[28:31], v[88:91], v[44:47], v[28:31]
    v_max_u32 v122, v122, v51
    v_cmp_eq_u32 vcc, -1, v122
    v_mfma_f32_16x16x32_bf16 v[32:35], v[92:95], v[44:47], v[32:35]
    s_bitcmp0_b32 s50, 3
    s_cbranch_scc1 Lk_t4
Lk_b3:
    s_cbranch_vccnz Lk_n3
    s_waitcnt lgkmcnt(2)
    v_mfma_f32_16x16x32_bf16 v[16:19], v[124:127], v[48:51], v[16:19]
    ds_read_b128 v[76:79], v10 offset:20480
    ds_read_b128 v[80:83], v10 offset:21504
    ds_read_b128 v[84:87], v10 offset:22528
    v_mfma_f32_16x16x32_bf16 v[20:23], v[128:131], v[48:51], v[20:23]
    ds_read_b128 v[88:91], v10 offset:23552
    ds_read_b128 v[92:95], v10 offset:24576
    s_bitset0_b32 s50, 3
    v_mfma_f32_16x16x32_bf16 v[24:27], v[132:135], v[48:51], v[24:27]
    s_waitcnt vmcnt(7)
    v_max3_u32 v122, v52, v53, v54
    s_waitcnt lgkmcnt(5)
    v_mfma_f32_16x16x32_bf16 v[28:31], v[136:139], v[48:51], v[28:31]
    v_max_u32 v122, v122, v55
    v_cmp_eq_u32 vcc, -1, v122
    v_mfma_f32_16x16x32_bf16 v[32:35], v[140:143], v[48:51], v[32:35]
    s_bitcmp0_b32 s50, 4
    s_cbranch_scc1 Lk_t5
Lk_b4:
    s_cbranch_vccnz Lk_n4
    s_waitcnt lgkmcnt(2)
    v_mfma_f32_16x16x32_bf16 v[16:19], v[76:79], v[52:55], v[16:19]
    ds_read_b128 v[124:127], v10 offset:25600
    ds_read_b128 v[128:131], v10 offset:26624
    ds_read_b128 v[132:135], v10 offset:27648
    v_mfma_f32_16x16x32_bf16 v[20:23], v[80:83], v[52:55], v[20:23]
    ds_read_b128 v[136:139], v10 offset:28672
    ds_read_b128 v[140:143], v10 offset:29696
    s_bitset0_b32 s50, 4
    v_mfma_f32_16x16x32_bf16 v[24:27], v[84:87], v[52:55], v[24:27]
    s_waitcnt vmcnt(6)
    v_max3_u32 v122, v56, v57, v58
    s_waitcnt lgkmcnt(5)
    v_mfma_f32_16x16x32_bf16 v[28:31], v[88:91], v[52:55], v[28:31]
    v_max_u32 v122, v122, v59
    v_cmp_eq_u32 vcc, -1, v122
    v_mfma_f32_16x16x32_bf16 v[32:35], v[92:95], v[52:55], v[32:35]
    s_bitcmp0_b32 s50, 5
    s_cbranch_scc1 Lk_t6
Lk_b5:
    s_cbranch_vccnz Lk_n5
    s_waitcnt lgkmcnt(2)
    v_mfma_f32_16x16x32_bf16 v[16:19], v[124:127], v[56:59], v[16:19]
    ds_read_b128 v[76:79], v10 offset:30720
    ds_read_b128 v[80:83], v10 offset:31744
    ds_read_b128 v[84:87], v10 offset:32768
    v_mfma_f32_16x16x32_bf16 v[20:23], v[128:131], v[56:59], v[20:23]
    ds_read_b128 v[88:91], v10 offset:33792
    ds_read_b128 v[92:95], v10 offset:34816
    s_bitset0_b32 s50, 5
    v_mfma_f32_16x16x32_bf16 v[24:27], v[132:135], v[56:59], v[24:27]
    s_waitcnt vmcnt(5)
    v_max3_u32 v122, v60, v61, v62
    s_waitcnt lgkmcnt(5)
    v_mfma_f32_16x16x32_bf16 v[28:31], v[136:139], v[56:59], v[28:31]
    v_max_u32 v122, v122, v63
    v_cmp_eq_u32 vcc, -1, v122
    v_mfma_f32_16x16x32_bf16 v[32:35], v[140:143], v[56:59], v[32:35]
    s_bitcmp0_b32 s50, 6
    s_cbranch_scc1 Lk_t7
Lk_b6:
    s_cbranch_vccnz Lk_n6
    s_waitcnt lgkmcnt(2)
    v_mfma_f32_16x16x32_bf16 v[16:19], v[76:79], v[60:63], v[16:19]
    ds_read_b128 v[124:127], v10 offset:35840
    ds_read_b128 v[128:131], v10 offset:36864
    ds_read_b128 v[132:135], v10 offset:37888
    v_mfma_f32_16x16x32_bf16 v[20:23], v[80:83], v[60:63], v[20:23]
    ds_read_b128 v[136:139], v10 offset:38912
    ds_read_b128 v[140:143], v10 offset:39936
    s_bitset0_b32 s50, 6
    v_mfma_f32_16x16x32_bf16 v[24:27], v[84:87], v[60:63], v[24:27]
    s_waitcnt vmcnt(4)
    v_max3_u32 v122, v64, v65, v66
    s_waitcnt lgkmcnt(5)
    v_mfma_f32_16x16x32_bf16 v[28:31], v[88:91], v[60:63], v[28:31]
    v_max_u32 v122, v122, v67
    v_cmp_eq_u32 vcc, -1, v122
    v_mfma_f32_16x16x32_bf16 v[32:35], v[92:95], v[60:63], v[32:35]
    s_bitcmp0_b32 s50, 7
    s_cbranch_scc1 Lk_t8
Lk_b7:
    s_cbranch_vccnz Lk_n7
    s_waitcnt lgkmcnt(2)
    v_mfma_f32_16x16x32_bf16 v[16:19], v[124:127], v[64:67], v[16:19]
    ds_read_b128 v[76:79], v10 offset:40960
    ds_read_b128 v[80:83], v10 offset:41984
    ds_read_b128 v[84:87], v10 offset:43008
    v_mfma_f32_16x16x32_bf16 v[20:23], v[128:131], v[64:67], v[20:23]
    ds_read_b128 v[88:91], v10 offset:44032
    ds_read_b128 v[92:95], v10 offset:45056
    s_bitset0_b32 s50, 7
    v_mfma_f32_16x16x32_bf16 v[24:27], v[132:135], v[64:67], v[24:27]
    s_waitcnt vmcnt(2)
    v_max3_u32 v122, v68, v69, v70
    s_waitcnt lgkmcnt(5)
    v_mfma_f32_16x16x32_bf16 v[28:31], v[136:139], v[64:67], v[28:31]
    v_max_u32 v122, v122, v71
    v_cmp_eq_u32 vcc, -1, v122
    v_mfma_f32_16x16x32_bf16 v[32:35], v[140:143], v[64:67], v[32:35]
    s_bitcmp0_b32 s50, 8
    s_cbranch_scc1 Lk_t9
Lk_b8:
    s_cbranch_vccnz Lk_n8
    s_waitcnt lgkmcnt(2)
    v_mfma_f32_16x16x32_bf16 v[16:19], v[76:79], v[68:71], v[16:19]
    ds_read_b128 v[124:127], v10 offset:46080
    ds_read_b128 v[128:131], v10 offset:47104
    ds_read_b128 v[132:135], v10 offset:48128
    v_mfma_f32_16x16x32_bf16 v[20:23], v[80:83], v[68:71], v[20:23]
    ds_read_b128 v[136:139], v10 offset:49152
    ds_read_b128 v[140:143], v10 offset:50176
    s_bitset0_b32 s50, 8
    v_mfma_f32_16x16x32_bf16 v[24:27], v[84:87], v[68:71], v[24:27]
    s_waitcnt vmcnt(0)
    v_max3_u32 v122, v72, v73, v74
    s_waitcnt lgkmcnt(5)
    v_mfma_f32_16x16x32_bf16 v[28:31], v[88:91], v[68:71], v[28:31]
    v_max_u32 v122, v122, v75
    v_cmp_eq_u32 vcc, -1, v122
    v_mfma_f32_16x16x32_bf16 v[32:35], v[92:95], v[68:71], v[32:35]
    s_bitcmp0_b32 s50, 9
    s_cbranch_scc1 Lk_t10
Lk_b9:
    s_cbranch_vccnz Lk_n9
    s_waitcnt lgkmcnt(2)
    v_mfma_f32_16x16x32_bf16 v[16:19], v[124:127], v[72:75], v[16:19]
    v_mfma_f32_16x16x32_bf16 v[20:23], v[128:131], v[72:75], v[20:23]
    s_bitset0_b32 s50, 9
    v_mfma_f32_16x16x32_bf16 v[24:27], v[132:135], v[72:75], v[24:27]
    s_waitcnt lgkmcnt(0)
    v_mfma_f32_16x16x32_bf16 v[28:31], v[136:139], v[72:75], v[28:31]
    v_mfma_f32_16x16x32_bf16 v[32:35], v[140:143], v[72:75], v[32:35]
Lk_t10:
    s_and_b32 s44, s49, 1
    s_or_b32 s44, s50, s44
    s_cbranch_scc1 Lk_post
Lk_fin:
    s_nop 2
    v_cvt_pk_bf16_f32 v112, v16, v17
    v_cvt_pk_bf16_f32 v113, v18, v19
    v_cvt_pk_bf16_f32 v114, v20, v21
    v_cvt_pk_bf16_f32 v115, v22, v23
    v_cvt_pk_bf16_f32 v116, v24, v25
    v_cvt_pk_bf16_f32 v117, v26, v27
    v_cvt_pk_bf16_f32 v118, v28, v29
    v_cvt_pk_bf16_f32 v119, v30, v31
    v_cvt_pk_bf16_f32 v120, v32, v33
    v_cvt_pk_bf16_f32 v121, v34, v35
    buffer_store_dwordx4 v[112:115], v6, s[28:31], 0 offen
    buffer_store_dwordx4 v[116:119], v6, s[28:31], 0 offen offset:16
    buffer_store_dwordx2 v[120:121], v6, s[28:31], 0 offen offset:32
    s_endpgm
Lk_post:
    ds_read_b32 v13, v15 offset:56
    s_cmp_lg_u32 s50, 0
    s_cbranch_scc1 Lk_again
    v_add_u32 v10, 51200, v1
    v_mov_b32 v5, v162
    v_mov_b32 v4, v163
    v_mov_b32 v162, 1073741824
    v_mov_b32 v163, 1073741824
    s_mov_b32 s49, 0
Lw59:
    ds_read_b32 v13, v15 offset:56
    s_waitcnt lgkmcnt(0)
    v_readfirstlane_b32 s47, v13
    s_cmp_ge_u32 s47, 8
    s_cbranch_scc1 Lwd60
    s_sub_u32 s92, s92, 1
    s_cbranch_scc1 Lwd60
    s_sleep 2
    s_branch Lw59
Lwd60:
    s_setprio 3
    s_branch Lk_bulk
Lk_again:
    s_sub_u32 s92, s92, 1
    s_cbranch_scc1 Lk_fin
    s_or_b32 s49, s49, 6
Lk_t0:
    s_bitcmp0_b32 s50, 0
    s_cbranch_scc1 Lk_t1
    ds_read_b128 v[76:79], v10 offset:0
    ds_read_b128 v[80:83], v10 offset:1024
    ds_read_b128 v[84:87], v10 offset:2048
    ds_read_b128 v[88:91], v10 offset:3072
    ds_read_b128 v[92:95], v10 offset:4096
    s_bitcmp0_b32 s49, 1
    s_cbranch_scc1 Lk_u0
    s_bitset0_b32 s49, 1
    s_waitcnt vmcnt(0)
Lk_u0:
    s_waitcnt vmcnt(11)
    v_max3_u32 v122, v36, v37, v38
    v_max_u32 v122, v122, v39
    v_cmp_eq_u32 vcc, -1, v122
    s_branch Lk_b0
Lk_n0:
    buffer_load_dwordx4 v[36:39], v5, s[24:27], s64 offen sc1
Lk_t1:
    s_bitcmp0_b32 s50, 1
    s_cbranch_scc1 Lk_t2
    ds_read_b128 v[124:127], v10 offset:5120
    ds_read_b128 v[128:131], v10 offset:6144
    ds_read_b128 v[132:135], v10 offset:7168
    ds_read_b128 v[136:139], v10 offset:8192
    ds_read_b128 v[140:143], v10 offset:9216
    s_bitcmp0_b32 s49, 1
    s_cbranch_scc1 Lk_u1
    s_bitset0_b32 s49, 1
    s_waitcnt vmcnt(0)
Lk_u1:
    s_waitcnt vmcnt(10)
    v_max3_u32 v122, v40, v41, v42
    v_max_u32 v122, v122, v43
    v_cmp_eq_u32 vcc, -1, v122
    s_branch Lk_b1
Lk_n1:
    buffer_load_dwordx4 v[40:43], v5, s[24:27], s65 offen sc1
Lk_t2:
    s_bitcmp0_b32 s50, 2
    s_cbranch_scc1 Lk_t3
    ds_read_b128 v[76:79], v10 offset:10240
    ds_read_b128 v[80:83], v10 offset:11264
    ds_read_b128 v[84:87], v10 offset:12288
    ds_read_b128 v[88:91], v10 offset:13312
    ds_read_b128 v[92:95], v10 offset:14336
    s_bitcmp0_b32 s49, 1
    s_cbranch_scc1 Lk_u2
    s_bitset0_b32 s49, 1
    s_waitcnt vmcnt(0)
Lk_u2:
    s_waitcnt vmcnt(9)
    v_max3_u32 v122, v44, v45, v46
    v_max_u32 v122, v122, v47
    v_cmp_eq_u32 vcc, -1, v122
    s_branch Lk_b2
Lk_n2:
    buffer_load_dwordx4 v[44:47], v5, s[24:27], s66 offen sc1
Lk_t3:
    s_bitcmp0_b32 s50, 3
    s_cbranch_scc1 Lk_t4
    ds_read_b128 v[124:127], v10 offset:15360
    ds_read_b128 v[128:131], v10 offset:16384
    ds_read_b128 v[132:135], v10 offset:17408
    ds_read_b128 v[136:139], v10 offset:18432
    ds_read_b128 v[140:143], v10 offset:19456
    s_bitcmp0_b32 s49, 1
    s_cbranch_scc1 Lk_u3
    s_bitset0_b32 s49, 1
    s_waitcnt vmcnt(0)
Lk_u3:
    s_waitcnt vmcnt(8)
    v_max3_u32 v122, v48, v49, v50
    v_max_u32 v122, v122, v51
    v_cmp_eq_u32 vcc, -1, v122
    s_branch Lk_b3
Lk_n3:
    buffer_load_dwordx4 v[48:51], v5, s[24:27], s67 offen sc1
Lk_t4:
    s_bitcmp0_b32 s50, 4
    s_cbranch_scc1 Lk_t5
    ds_read_b128 v[76:79], v10 offset:20480
    ds_read_b128 v[80:83], v10 offset:21504
    ds_read_b128 v[84:87], v10 offset:22528
    ds_read_b128 v[88:91], v10 offset:23552
    ds_read_b128 v[92:95], v10 offset:24576
    s_bitcmp0_b32 s49, 1
    s_cbranch_scc1 Lk_u4
    s_bitset0_b32 s49, 1
    s_waitcnt vmcnt(0)
Lk_u4:
    s_waitcnt vmcnt(7)
    v_max3_u32 v122, v52, v53, v54
    v_max_u32 v122, v122, v55
    v_cmp_eq_u32 vcc, -1, v122
    s_branch Lk_b4
Lk_n4:
    buffer_load_dwordx4 v[52:55], v5, s[24:27], s68 offen sc1
Lk_t5:
    s_bitcmp0_b32 s50, 5
    s_cbranch_scc1 Lk_t6
    ds_read_b128 v[124:127], v10 offset:25600
    ds_read_b128 v[128:131], v10 offset:26624
    ds_read_b128 v[132:135], v10 offset:27648
    ds_read_b128 v[136:139], v10 offset:28672
    ds_read_b128 v[140:143], v10 offset:29696
    s_bitcmp0_b32 s49, 1
    s_cbranch_scc1 Lk_u5
    s_bitset0_b32 s49, 1
    s_waitcnt vmcnt(0)
Lk_u5:
    s_waitcnt vmcnt(6)
    v_max3_u32 v122, v56, v57, v58
    v_max_u32 v122, v122, v59
    v_cmp_eq_u32 vcc, -1, v122
    s_branch Lk_b5
Lk_n5:
    buffer_load_dwordx4 v[56:59], v5, s[24:27], s69 offen sc1
Lk_t6:
    s_bitcmp0_b32 s50, 6
    s_cbranch_scc1 Lk_t7
    ds_read_b128 v[76:79], v10 offset:30720
    ds_read_b128 v[80:83], v10 offset:31744
    ds_read_b128 v[84:87], v10 offset:32768
    ds_read_b128 v[88:91], v10 offset:33792
    ds_read_b128 v[92:95], v10 offset:34816
    s_bitcmp0_b32 s49, 1
    s_cbranch_scc1 Lk_u6
    s_bitset0_b32 s49, 1
    s_waitcnt vmcnt(0)
Lk_u6:
    s_waitcnt vmcnt(5)
    v_max3_u32 v122, v60, v61, v62
    v_max_u32 v122, v122, v63
    v_cmp_eq_u32 vcc, -1, v122
    s_branch Lk_b6
Lk_n6:
    buffer_load_dwordx4 v[60:63], v5, s[24:27], s70 offen sc1
Lk_t7:
    s_bitcmp0_b32 s50, 7
    s_cbranch_scc1 Lk_t8
    ds_read_b128 v[124:127], v10 offset:35840
    ds_read_b128 v[128:131], v10 offset:36864
    ds_read_b128 v[132:135], v10 offset:37888
    ds_read_b128 v[136:139], v10 offset:38912
    ds_read_b128 v[140:143], v10 offset:39936
    s_bitcmp0_b32 s49, 1
    s_cbranch_scc1 Lk_u7
    s_bitset0_b32 s49, 1
    s_waitcnt vmcnt(0)
Lk_u7:
    s_waitcnt vmcnt(4)
    v_max3_u32 v122, v64, v65, v66
    v_max_u32 v122, v122, v67
    v_cmp_eq_u32 vcc, -1, v122
    s_branch Lk_b7
Lk_n7:
    buffer_load_dwordx4 v[64:67], v5, s[24:27], s71 offen sc1
Lk_t8:
    s_bitcmp0_b32 s50, 8
    s_cbranch_scc1 Lk_t9
    ds_read_b128 v[76:79], v10 offset:40960
    ds_read_b128 v[80:83], v10 offset:41984
    ds_read_b128 v[84:87], v10 offset:43008
    ds_read_b128 v[88:91], v10 offset:44032
    ds_read_b128 v[92:95], v10 offset:45056
    s_bitcmp0_b32 s49, 1
    s_cbranch_scc1 Lk_u8
    s_bitset0_b32 s49, 1
    s_waitcnt vmcnt(0)
Lk_u8:
    s_waitcnt vmcnt(2)
    v_max3_u32 v122, v68, v69, v70
    v_max_u32 v122, v122, v71
    v_cmp_eq_u32 vcc, -1, v122
    s_branch Lk_b8
Lk_n8:
    buffer_load_dwordx2 v[68:69], v4, s[24:27], s72 offen sc1
    buffer_load_dwordx2 v[70:71], v4, s[24:27], s73 offen sc1
Lk_t9:
    s_bitcmp0_b32 s50, 9
    s_cbranch_scc1 Lk_t10
    ds_read_b128 v[124:127], v10 offset:46080
    ds_read_b128 v[128:131], v10 offset:47104
    ds_read_b128 v[132:135], v10 offset:48128
    ds_read_b128 v[136:139], v10 offset:49152
    ds_read_b128 v[140:143], v10 offset:50176
    s_bitcmp0_b32 s49, 1
    s_cbranch_scc1 Lk_u9
    s_bitset0_b32 s49, 1
    s_waitcnt vmcnt(0)
Lk_u9:
    s_waitcnt vmcnt(0)
    v_max3_u32 v122, v72, v73, v74
    v_max_u32 v122, v122, v75
    v_cmp_eq_u32 vcc, -1, v122
    s_branch Lk_b9
Lk_n9:
    buffer_load_dwordx2 v[72:73], v4, s[24:27], s74 offen sc1
    buffer_load_dwordx2 v[74:75], v4, s[24:27], s75 offen sc1
    s_branch Lk_t10
Lfallback:
    v_mov_b32 v104, v100
    v_mov_b32 v105, v101
    v_lshlrev_b32 v156, 4, v0
    v_bfe_u32 v88, v0, 4, 1
    v_lshrrev_b32 v89, 5, v0
    v_xor_b32 v89, v89, v88
    v_lshl_add_u32 v89, v88, 1, v89
    v_and_b32 v88, 15, v0
    v_lshl_add_u32 v89, v89, 4, v88
    v_lshlrev_b32 v157, 2, v89
    v_add_u32 v157, 1024, v157
    v_and_b32 v88, 31, v0
    v_lshrrev_b32 v89, 5, v0
    v_mul_u32_u24 v89, 20, v89
    v_add_u32 v89, v88, v89
    v_lshlrev_b32 v89, 4, v89
    v_add_u32 v89, 1280, v89
    v_cmp_eq_u32 vcc, 20, v88
    v_mov_b32 v90, 1073741824
    v_mov_b32 v91, 2560
    v_mov_b32 v92, 0x3F803F80
    v_mov_b32 v93, 0
    v_cndmask_b32 v90, v90, v91, vcc
    v_cndmask_b32 v144, v93, v92, vcc
    v_cndmask_b32 v145, v93, v92, vcc
    v_cndmask_b32 v146, v93, v92, vcc
    v_cndmask_b32 v147, v93, v92, vcc
    v_cndmask_b32 v148, v93, v92, vcc
    v_cndmask_b32 v149, v93, v92, vcc
    v_cndmask_b32 v150, v93, v92, vcc
    v_cndmask_b32 v151, v93, v92, vcc
    v_cmp_gt_u32 vcc, 20, v88
    v_add_u32 v91, 640, v89
    s_nop 0
    v_cndmask_b32 v158, v90, v89, vcc
    v_cndmask_b32 v159, v90, v91, vcc
    v_mov_b32 v155, 0
    v_mov_b32 v106, 0xff800000
    v_and_b32 v11, 15, v0
    v_lshrrev_b32 v12, 5, v0
    v_lshl_add_u32 v12, v12, 4, v11
    v_lshlrev_b32 v12, 4, v12
    v_bfe_u32 v13, v0, 4, 1
    v_lshl_add_u32 v156, v13, 10, v12
    v_cmp_eq_u32 vcc, 1, v13
    v_add_u32 v12, 4096, v12
    v_add_u32 v11, 8, v12
    v_cndmask_b32 v158, v12, v11, vcc
    v_add_u32 v12, 4, v12
    v_add_u32 v11, 64, v11
    v_cndmask_b32 v159, v12, v11, vcc
    s_mov_b32 s46, 0
Lfb1:
    buffer_load_dwordx2 v[72:73], v156, s[24:27], s46 offen sc1
    buffer_load_dwordx2 v[74:75], v156, s[24:27], s46 offen offset:512 sc1
    buffer_load_dword v152, v156, s[24:27], s46 offen offset:8 sc1
    s_waitcnt vmcnt(0)
    v_mfma_f32_32x32x8_bf16 v[16:31], v[152:153], v[154:155], 0
    v_mfma_f32_32x32x16_bf16 v[16:31], v[72:75], v[76:79], v[16:31]
    s_nop 7
    s_nop 7
    v_max3_f32 v100, v16, v17, v18
    v_max3_f32 v100, v100, v19, v20
    v_max3_f32 v100, v100, v21, v22
    v_max3_f32 v100, v100, v23, v24
    v_max3_f32 v100, v100, v25, v26
    v_max3_f32 v100, v100, v27, v28
    v_max3_f32 v100, v100, v29, v30
    v_max_f32 v100, v100, v31
    v_max_f32 v106, v106, v100
    s_add_u32 s46, s46, 2048
    s_and_b32 s47, s46, 4096
    s_add_u32 s46, s46, s47
    s_cmp_lt_u32 s46, 262144
    s_cbranch_scc1 Lfb1
    v_mov_b32 v100, v106
    s_nop 1
    v_permlane32_swap_b32 v100, v106
    s_nop 1
    v_max_f32 v106, v106, v100
    v_mov_b32 v48, 0
    v_mov_b32 v49, 0
    v_mov_b32 v50, 0
    v_mov_b32 v51, 0
    v_mov_b32 v52, 0
    v_mov_b32 v53, 0
    v_mov_b32 v54, 0
    v_mov_b32 v55, 0
    v_mov_b32 v56, 0
    v_mov_b32 v57, 0
    v_mov_b32 v58, 0
    v_mov_b32 v59, 0
    v_mov_b32 v60, 0
    v_mov_b32 v61, 0
    v_mov_b32 v62, 0
    v_mov_b32 v63, 0
    s_mov_b32 s46, 0
Lfb2:
    buffer_load_dwordx2 v[72:73], v156, s[24:27], s46 offen sc1
    buffer_load_dwordx2 v[74:75], v156, s[24:27], s46 offen offset:512 sc1
    buffer_load_dword v152, v156, s[24:27], s46 offen offset:8 sc1
    s_mov_b64 exec, s[94:95]
    buffer_load_dword v144, v158, s[24:27], s46 offen offset:0 sc1
    buffer_load_dword v145, v159, s[24:27], s46 offen offset:0 sc1
    buffer_load_dword v146, v158, s[24:27], s46 offen offset:512 sc1
    buffer_load_dword v147, v159, s[24:27], s46 offen offset:512 sc1
    buffer_load_dword v148, v158, s[24:27], s46 offen offset:1024 sc1
    buffer_load_dword v149, v159, s[24:27], s46 offen offset:1024 sc1
    buffer_load_dword v150, v158, s[24:27], s46 offen offset:1536 sc1
    buffer_load_dword v151, v159, s[24:27], s46 offen offset:1536 sc1
    s_mov_b64 exec, -1
    s_waitcnt vmcnt(0)
    v_mfma_f32_32x32x8_bf16 v[16:31], v[152:153], v[154:155], 0
    v_mfma_f32_32x32x16_bf16 v[16:31], v[72:75], v[76:79], v[16:31]
    s_nop 7
    s_nop 7
    v_sub_f32 v16, v16, v106
    v_sub_f32 v17, v17, v106
    v_sub_f32 v18, v18, v106
    v_sub_f32 v19, v19, v106
    v_sub_f32 v20, v20, v106
    v_sub_f32 v21, v21, v106
    v_sub_f32 v22, v22, v106
    v_sub_f32 v23, v23, v106
    v_sub_f32 v24, v24, v106
    v_sub_f32 v25, v25, v106
    v_sub_f32 v26, v26, v106
    v_sub_f32 v27, v27, v106
    v_sub_f32 v28, v28, v106
    v_sub_f32 v29, v29, v106
    v_sub_f32 v30, v30, v106
    v_sub_f32 v31, v31, v106
    v_exp_f32 v16, v16
    v_exp_f32 v17, v17
    v_exp_f32 v18, v18
    v_exp_f32 v19, v19
    v_exp_f32 v20, v20
    v_exp_f32 v21, v21
    v_exp_f32 v22, v22
    v_exp_f32 v23, v23
    v_exp_f32 v24, v24
    v_exp_f32 v25, v25
    v_exp_f32 v26, v26
    v_exp_f32 v27, v27
    v_exp_f32 v28, v28
    v_exp_f32 v29, v29
    v_exp_f32 v30, v30
    v_exp_f32 v31, v31
    s_nop 0
    v_cvt_pk_bf16_f32 v64, v16, v17
    v_cvt_pk_bf16_f32 v65, v18, v19
    v_cvt_pk_bf16_f32 v66, v20, v21
    v_cvt_pk_bf16_f32 v67, v22, v23
    v_cvt_pk_bf16_f32 v68, v24, v25
    v_cvt_pk_bf16_f32 v69, v26, v27
    v_cvt_pk_bf16_f32 v70, v28, v29
    v_cvt_pk_bf16_f32 v71, v30, v31
    s_nop 1
    v_mfma_f32_32x32x16_bf16 v[48:63], v[144:147], v[64:67], v[48:63]
    v_mfma_f32_32x32x16_bf16 v[48:63], v[148:151], v[68:71], v[48:63]
    s_add_u32 s46, s46, 2048
    s_and_b32 s47, s46, 4096
    s_add_u32 s46, s46, s47
    s_cmp_lt_u32 s46, 262144
    s_nop 7
    s_cbranch_scc1 Lfb2
    s_nop 7
    s_nop 7
    v_mov_b32 v102, v56
    v_mov_b32 v103, v56
    v_mov_b32 v100, v104
    v_mov_b32 v101, v105
    v_permlane32_swap_b32 v102, v103
    s_nop 1
    v_rcp_f32 v98, v103
    s_nop 0
    s_branch Lattn_epi
Lend:
    s_endpgm
.section .rodata,"a"
.p2align 6
.amdhsa_kernel gated_mix__grouped_kv_mqa__spectral_fnet__prompt_kernel
  .amdhsa_next_free_vgpr 168
  .amdhsa_next_free_sgpr 102
  .amdhsa_accum_offset 168
  .amdhsa_group_segment_fixed_size 0
  .amdhsa_kernarg_size 112
  .amdhsa_user_sgpr_count 2
  .amdhsa_user_sgpr_kernarg_segment_ptr 1
  .amdhsa_system_sgpr_workgroup_id_x 1
.end_amdhsa_kernel
```
